```python
import torch

def _softmax(x, axis=-1):
    return torch.softmax(x, dim=axis)
def _gelu(x):
    return torch.nn.functional.gelu(x, approximate="tanh")
def _silu(x):
    return torch.nn.functional.silu(x)
def _sigmoid(x):
    return torch.sigmoid(x)
def _layernorm(x, axis=-1, eps=1e-5):
    m = x.mean(dim=axis, keepdim=True)
    v = x.var(dim=axis, keepdim=True, unbiased=False)
    return (x - m) / torch.sqrt(v + eps)
def _scatter_add(tgt, idx, src, axis=0):
    return tgt.clone().index_add_(axis, idx, src)
def _segment_sum(src, seg, n):
    out = torch.zeros((n,) + src.shape[1:], dtype=src.dtype)
    return out.index_add_(0, seg, src)
def _pad(x, pw):
    flat = tuple(v for pair in reversed(pw) for v in pair)
    return torch.nn.functional.pad(x, flat)

kernel_name = 'recurrent_scan__gqa_block_cached__glu_gated_geglu__decode'

def setup_inputs():

    _w = (lambda a: (lambda t: t.to(torch.bfloat16) if t.is_floating_point() else t)(torch.as_tensor(a)))
    def _A_setup():
        B, Sq, D = 1, 1, 576
        Hq, Hkv, Sk, Dh = 32, 16, 65536, 128
        assert Hq % Hkv == 0, (Hq, Hkv)
        return {
            "x": _w((lambda *s: torch.randn(*s, dtype=torch.bfloat16) * 0.4)(B, Sq, D)),
            "k_cache": _w((lambda *s: torch.randn(*s, dtype=torch.bfloat16) * 1.6)(B, Hkv, Sk, Dh)),
            "v_cache": _w((lambda *s: torch.randn(*s, dtype=torch.bfloat16) * 1.6)(B, Hkv, Sk, Dh)),
            "wq": _w((lambda *s: torch.randn(*s, dtype=torch.bfloat16) * 1.6)(D, Hq * Dh) * (D ** -0.5)),
            "wo": _w((lambda *s: torch.randn(*s, dtype=torch.bfloat16) * 1.6)(Hq * Dh, D) * ((Hq * Dh) ** -0.5)),
        }
    _A_in = _A_setup()

    def _B_setup():
        B, S, Dm, Df = 1, 1, 576, 4608
        return {
            "x": _w((lambda *s: torch.randn(*s, dtype=torch.bfloat16) * 0.4)(B, S, Dm)),
            "w_gate": _w((lambda *s: torch.randn(*s, dtype=torch.bfloat16) * 1.6)(Dm, Df) * (Dm ** -0.5)),
            "w_up": _w((lambda *s: torch.randn(*s, dtype=torch.bfloat16) * 1.6)(Dm, Df) * (Dm ** -0.5)),
            "w_down": _w((lambda *s: torch.randn(*s, dtype=torch.bfloat16) * 1.6)(Df, Dm) * (Df ** -0.5)),
        }
    _B_in = _B_setup()

    return {
        "A_x": _A_in["x"],
        "A_k_cache": _A_in["k_cache"],
        "A_v_cache": _A_in["v_cache"],
        "A_wq": _A_in["wq"],
        "A_wo": _A_in["wo"],
        "B_x": _B_in["x"],
        "B_w_gate": _B_in["w_gate"],
        "B_w_up": _B_in["w_up"],
        "B_w_down": _B_in["w_down"],
    }

def reference(A_x, A_k_cache, A_v_cache, A_wq, A_wo, B_x, B_w_gate, B_w_up, B_w_down):
    def _A_ref(x, k_cache, v_cache, wq, wo):
        B, Sq, D = x.shape
        Hq, Dh = 32, 128
        Hkv = k_cache.shape[1]
        rep = Hq // Hkv
        q = (lambda x, *d: x.permute(*d))((x @ wq).reshape(B, Sq, Hq, Dh), 0, 2, 1, 3)
        k = (lambda x, n, axis: torch.repeat_interleave(x, n, dim=axis))(k_cache, rep, axis=1)
        v = (lambda x, n, axis: torch.repeat_interleave(x, n, dim=axis))(v_cache, rep, axis=1)
        scores = torch.einsum("bhqd,bhkd->bhqk", q, k) * (Dh ** -0.5)
        p = _softmax(scores, axis=-1)
        o = torch.einsum("bhqk,bhkd->bhqd", p, v)
        return (lambda x, *d: x.permute(*d))(o, 0, 2, 1, 3).reshape(B, Sq, Hq * Dh) @ wo

    def _B_ref(x, w_gate, w_up, w_down):
        g = torch.einsum("bsd,df->bsf", x, w_gate)
        u = torch.einsum("bsd,df->bsf", x, w_up)
        h = _gelu(g) * u
        return torch.einsum("bsf,fd->bsd", h, w_down)

    x = A_x
    xn = _layernorm(x, axis=-1)
    s = _A_ref(xn, A_k_cache, A_v_cache, A_wq, A_wo)
    g = _silu(_B_ref(xn, B_w_gate, B_w_up, B_w_down))
    return x + s * g
```

```asm
; @launch kernel=proj_kernel grid=(208,1,1) block=(256,1,1) lds=12288
; @launch kernel=attn_kernel grid=(1024,1,1) block=(256,1,1) lds=16640
; @launch kernel=out_kernel grid=(272,1,1) block=(288,1,1) lds=11264
; @launch kernel=fin_kernel grid=(9,1,1) block=(256,1,1) lds=2048
.amdgcn_target "amdgcn-amd-amdhsa--gfx950"
.text
.p2align 8
.type proj_kernel,@function
proj_kernel:
    s_cmp_ge_u32 s2, 208
    s_cbranch_scc1 K1_exit
    s_load_dwordx2 s[4:5], s[0:1], 0
    s_load_dwordx2 s[6:7], s[0:1], 24
    s_load_dwordx4 s[8:11], s[0:1], 48
    s_load_dwordx2 s[12:13], s[0:1], 88
    v_and_b32 v1, 7, v0
    v_lshrrev_b32 v2, 3, v0
    v_and_b32 v3, 63, v0
    v_lshlrev_b32 v4, 4, v3
    s_waitcnt lgkmcnt(0)
    s_mov_b32 s16, s4
    s_mov_b32 s17, s5
    s_mov_b32 s18, 1152
    s_mov_b32 s19, 0x00020000
    buffer_load_dwordx4 v[8:11], v4, s[16:19], 0 offen
    buffer_load_dwordx4 v[12:15], v4, s[16:19], 0 offen offset:1024
    s_cmp_ge_u32 s2, 64
    s_cbranch_scc1 K1_mlp_addr
    s_lshl_b32 s20, s2, 7
    s_add_u32 s22, s6, s20
    s_addc_u32 s23, s7, 0
    v_lshlrev_b32 v5, 4, v1
    v_lshl_add_u32 v5, v2, 13, v5
    s_mov_b32 s24, 262144
    v_mov_b32 v6, s22
    v_mov_b32 v7, s23
    s_branch K1_addr_done
K1_mlp_addr:
    s_sub_u32 s20, s2, 64
    s_lshl_b32 s20, s20, 6
    v_cmp_gt_u32 vcc, 4, v1
    v_mov_b32 v6, s10
    v_mov_b32 v7, s11
    v_mov_b32 v16, s8
    v_mov_b32 v17, s9
    v_cndmask_b32 v6, v6, v16, vcc
    v_cndmask_b32 v7, v7, v17, vcc
    v_and_b32 v5, 3, v1
    v_lshlrev_b32 v5, 4, v5
    v_mul_u32_u24 v16, 9216, v2
    v_add_u32 v5, v5, v16
    v_add_u32 v5, s20, v5
    s_mov_b32 s24, 294912
K1_addr_done:
    v_add_co_u32 v6, vcc, v6, v5
    s_nop 1
    v_addc_co_u32 v7, vcc, 0, v7, vcc
    global_load_dwordx4 v[32:35], v[6:7], off
    v_add_co_u32 v6, vcc, s24, v6
    s_nop 1
    v_addc_co_u32 v7, vcc, 0, v7, vcc
    global_load_dwordx4 v[36:39], v[6:7], off
    v_add_co_u32 v6, vcc, s24, v6
    s_nop 1
    v_addc_co_u32 v7, vcc, 0, v7, vcc
    global_load_dwordx4 v[40:43], v[6:7], off
    v_add_co_u32 v6, vcc, s24, v6
    s_nop 1
    v_addc_co_u32 v7, vcc, 0, v7, vcc
    global_load_dwordx4 v[44:47], v[6:7], off
    v_add_co_u32 v6, vcc, s24, v6
    s_nop 1
    v_addc_co_u32 v7, vcc, 0, v7, vcc
    global_load_dwordx4 v[48:51], v[6:7], off
    v_add_co_u32 v6, vcc, s24, v6
    s_nop 1
    v_addc_co_u32 v7, vcc, 0, v7, vcc
    global_load_dwordx4 v[52:55], v[6:7], off
    v_add_co_u32 v6, vcc, s24, v6
    s_nop 1
    v_addc_co_u32 v7, vcc, 0, v7, vcc
    global_load_dwordx4 v[56:59], v[6:7], off
    v_add_co_u32 v6, vcc, s24, v6
    s_nop 1
    v_addc_co_u32 v7, vcc, 0, v7, vcc
    global_load_dwordx4 v[60:63], v[6:7], off
    v_add_co_u32 v6, vcc, s24, v6
    s_nop 1
    v_addc_co_u32 v7, vcc, 0, v7, vcc
    global_load_dwordx4 v[64:67], v[6:7], off
    v_add_co_u32 v6, vcc, s24, v6
    s_nop 1
    v_addc_co_u32 v7, vcc, 0, v7, vcc
    global_load_dwordx4 v[68:71], v[6:7], off
    v_add_co_u32 v6, vcc, s24, v6
    s_nop 1
    v_addc_co_u32 v7, vcc, 0, v7, vcc
    global_load_dwordx4 v[72:75], v[6:7], off
    v_add_co_u32 v6, vcc, s24, v6
    s_nop 1
    v_addc_co_u32 v7, vcc, 0, v7, vcc
    global_load_dwordx4 v[76:79], v[6:7], off
    v_add_co_u32 v6, vcc, s24, v6
    s_nop 1
    v_addc_co_u32 v7, vcc, 0, v7, vcc
    global_load_dwordx4 v[80:83], v[6:7], off
    v_add_co_u32 v6, vcc, s24, v6
    s_nop 1
    v_addc_co_u32 v7, vcc, 0, v7, vcc
    global_load_dwordx4 v[84:87], v[6:7], off
    v_add_co_u32 v6, vcc, s24, v6
    s_nop 1
    v_addc_co_u32 v7, vcc, 0, v7, vcc
    global_load_dwordx4 v[88:91], v[6:7], off
    v_add_co_u32 v6, vcc, s24, v6
    s_nop 1
    v_addc_co_u32 v7, vcc, 0, v7, vcc
    global_load_dwordx4 v[92:95], v[6:7], off
    v_add_co_u32 v6, vcc, s24, v6
    s_nop 1
    v_addc_co_u32 v7, vcc, 0, v7, vcc
    global_load_dwordx4 v[96:99], v[6:7], off
    v_add_co_u32 v6, vcc, s24, v6
    s_nop 1
    v_addc_co_u32 v7, vcc, 0, v7, vcc
    global_load_dwordx4 v[100:103], v[6:7], off
    s_waitcnt vmcnt(18)
    v_lshlrev_b32 v104, 16, v8
    v_and_b32 v105, 0xffff0000, v8
    v_lshlrev_b32 v106, 16, v9
    v_and_b32 v107, 0xffff0000, v9
    v_lshlrev_b32 v108, 16, v10
    v_and_b32 v109, 0xffff0000, v10
    v_lshlrev_b32 v110, 16, v11
    v_and_b32 v111, 0xffff0000, v11
    v_lshlrev_b32 v112, 16, v12
    v_and_b32 v113, 0xffff0000, v12
    v_lshlrev_b32 v114, 16, v13
    v_and_b32 v115, 0xffff0000, v13
    v_lshlrev_b32 v116, 16, v14
    v_and_b32 v117, 0xffff0000, v14
    v_lshlrev_b32 v118, 16, v15
    v_and_b32 v119, 0xffff0000, v15
    v_add_f32 v16, v104, v105
    v_mul_f32 v17, v104, v104
    v_fmac_f32 v17, v105, v105
    v_add_f32 v16, v16, v106
    v_fmac_f32 v17, v106, v106
    v_add_f32 v16, v16, v107
    v_fmac_f32 v17, v107, v107
    v_add_f32 v16, v16, v108
    v_fmac_f32 v17, v108, v108
    v_add_f32 v16, v16, v109
    v_fmac_f32 v17, v109, v109
    v_add_f32 v16, v16, v110
    v_fmac_f32 v17, v110, v110
    v_add_f32 v16, v16, v111
    v_fmac_f32 v17, v111, v111
    v_add_f32 v16, v16, v112
    v_fmac_f32 v17, v112, v112
    v_add_f32 v16, v16, v113
    v_fmac_f32 v17, v113, v113
    v_add_f32 v16, v16, v114
    v_fmac_f32 v17, v114, v114
    v_add_f32 v16, v16, v115
    v_fmac_f32 v17, v115, v115
    v_add_f32 v16, v16, v116
    v_fmac_f32 v17, v116, v116
    v_add_f32 v16, v16, v117
    v_fmac_f32 v17, v117, v117
    v_add_f32 v16, v16, v118
    v_fmac_f32 v17, v118, v118
    v_add_f32 v16, v16, v119
    v_fmac_f32 v17, v119, v119
    s_nop 1
    v_add_f32_dpp v16, v16, v16 quad_perm:[1,0,3,2] row_mask:0xf bank_mask:0xf
    v_add_f32_dpp v17, v17, v17 quad_perm:[1,0,3,2] row_mask:0xf bank_mask:0xf
    s_nop 1
    v_add_f32_dpp v16, v16, v16 quad_perm:[2,3,0,1] row_mask:0xf bank_mask:0xf
    v_add_f32_dpp v17, v17, v17 quad_perm:[2,3,0,1] row_mask:0xf bank_mask:0xf
    s_nop 1
    v_add_f32_dpp v16, v16, v16 row_half_mirror row_mask:0xf bank_mask:0xf
    v_add_f32_dpp v17, v17, v17 row_half_mirror row_mask:0xf bank_mask:0xf
    s_nop 1
    v_add_f32_dpp v16, v16, v16 row_mirror row_mask:0xf bank_mask:0xf
    v_add_f32_dpp v17, v17, v17 row_mirror row_mask:0xf bank_mask:0xf
    s_nop 1
    s_nop 0
    v_readlane_b32 s28, v16, 0
    v_readlane_b32 s29, v16, 16
    v_readlane_b32 s30, v16, 32
    v_readlane_b32 s31, v16, 48
    v_readlane_b32 s32, v17, 0
    v_readlane_b32 s33, v17, 16
    v_readlane_b32 s34, v17, 32
    v_readlane_b32 s35, v17, 48
    s_nop 1
    v_mov_b32 v16, s28
    v_add_f32 v16, s29, v16
    v_add_f32 v16, s30, v16
    v_add_f32 v16, s31, v16
    v_mov_b32 v17, s32
    v_add_f32 v17, s33, v17
    v_add_f32 v17, s34, v17
    v_add_f32 v17, s35, v17
    v_mul_f32 v16, 0x3ae38e39, v16
    v_mul_f32 v17, 0x3ae38e39, v17
    v_fma_f32 v17, -v16, v16, v17
    v_cvt_pk_bf16_f32 v18, v16, v17
    v_lshlrev_b32 v16, 16, v18
    v_and_b32 v17, 0xffff0000, v18
    v_add_f32 v17, 0x3727c5ac, v17
    v_cvt_pk_bf16_f32 v18, v17, v17
    v_lshlrev_b32 v17, 16, v18
    v_sqrt_f32 v17, v17
    s_nop 0
    v_cvt_pk_bf16_f32 v18, v17, v17
    v_lshlrev_b32 v17, 16, v18
    v_rcp_f32 v17, v17
    s_nop 0
    v_sub_f32 v104, v104, v16
    v_sub_f32 v105, v105, v16
    v_sub_f32 v106, v106, v16
    v_sub_f32 v107, v107, v16
    v_sub_f32 v108, v108, v16
    v_sub_f32 v109, v109, v16
    v_sub_f32 v110, v110, v16
    v_sub_f32 v111, v111, v16
    v_sub_f32 v112, v112, v16
    v_sub_f32 v113, v113, v16
    v_sub_f32 v114, v114, v16
    v_sub_f32 v115, v115, v16
    v_sub_f32 v116, v116, v16
    v_sub_f32 v117, v117, v16
    v_sub_f32 v118, v118, v16
    v_sub_f32 v119, v119, v16
    v_cvt_pk_bf16_f32 v18, v104, v105
    v_lshlrev_b32 v104, 16, v18
    v_and_b32 v105, 0xffff0000, v18
    v_cvt_pk_bf16_f32 v18, v106, v107
    v_lshlrev_b32 v106, 16, v18
    v_and_b32 v107, 0xffff0000, v18
    v_cvt_pk_bf16_f32 v18, v108, v109
    v_lshlrev_b32 v108, 16, v18
    v_and_b32 v109, 0xffff0000, v18
    v_cvt_pk_bf16_f32 v18, v110, v111
    v_lshlrev_b32 v110, 16, v18
    v_and_b32 v111, 0xffff0000, v18
    v_cvt_pk_bf16_f32 v18, v112, v113
    v_lshlrev_b32 v112, 16, v18
    v_and_b32 v113, 0xffff0000, v18
    v_cvt_pk_bf16_f32 v18, v114, v115
    v_lshlrev_b32 v114, 16, v18
    v_and_b32 v115, 0xffff0000, v18
    v_cvt_pk_bf16_f32 v18, v116, v117
    v_lshlrev_b32 v116, 16, v18
    v_and_b32 v117, 0xffff0000, v18
    v_cvt_pk_bf16_f32 v18, v118, v119
    v_lshlrev_b32 v118, 16, v18
    v_and_b32 v119, 0xffff0000, v18
    v_mul_f32 v104, v104, v17
    v_mul_f32 v105, v105, v17
    v_mul_f32 v106, v106, v17
    v_mul_f32 v107, v107, v17
    v_mul_f32 v108, v108, v17
    v_mul_f32 v109, v109, v17
    v_mul_f32 v110, v110, v17
    v_mul_f32 v111, v111, v17
    v_mul_f32 v112, v112, v17
    v_mul_f32 v113, v113, v17
    v_mul_f32 v114, v114, v17
    v_mul_f32 v115, v115, v17
    v_mul_f32 v116, v116, v17
    v_mul_f32 v117, v117, v17
    v_mul_f32 v118, v118, v17
    v_mul_f32 v119, v119, v17
    v_cvt_pk_bf16_f32 v18, v104, v105
    v_lshlrev_b32 v104, 16, v18
    v_and_b32 v105, 0xffff0000, v18
    v_cvt_pk_bf16_f32 v18, v106, v107
    v_lshlrev_b32 v106, 16, v18
    v_and_b32 v107, 0xffff0000, v18
    v_cvt_pk_bf16_f32 v18, v108, v109
    v_lshlrev_b32 v108, 16, v18
    v_and_b32 v109, 0xffff0000, v18
    v_cvt_pk_bf16_f32 v18, v110, v111
    v_lshlrev_b32 v110, 16, v18
    v_and_b32 v111, 0xffff0000, v18
    v_cvt_pk_bf16_f32 v18, v112, v113
    v_lshlrev_b32 v112, 16, v18
    v_and_b32 v113, 0xffff0000, v18
    v_cvt_pk_bf16_f32 v18, v114, v115
    v_lshlrev_b32 v114, 16, v18
    v_and_b32 v115, 0xffff0000, v18
    v_cvt_pk_bf16_f32 v18, v116, v117
    v_lshlrev_b32 v116, 16, v18
    v_and_b32 v117, 0xffff0000, v18
    v_cvt_pk_bf16_f32 v18, v118, v119
    v_lshlrev_b32 v118, 16, v18
    v_and_b32 v119, 0xffff0000, v18
    v_lshlrev_b32 v18, 5, v3
    ds_write_b128 v18, v[104:107]
    ds_write_b128 v18, v[108:111] offset:16
    ds_write_b128 v18, v[112:115] offset:2048
    ds_write_b128 v18, v[116:119] offset:2064
    s_waitcnt lgkmcnt(0)
    v_lshlrev_b32 v18, 2, v2
    ds_read_b32 v104, v18 offset:0
    ds_read_b32 v105, v18 offset:128
    ds_read_b32 v106, v18 offset:256
    ds_read_b32 v107, v18 offset:384
    ds_read_b32 v108, v18 offset:512
    ds_read_b32 v109, v18 offset:640
    ds_read_b32 v110, v18 offset:768
    ds_read_b32 v111, v18 offset:896
    ds_read_b32 v112, v18 offset:1024
    ds_read_b32 v113, v18 offset:1152
    ds_read_b32 v114, v18 offset:1280
    ds_read_b32 v115, v18 offset:1408
    ds_read_b32 v116, v18 offset:1536
    ds_read_b32 v117, v18 offset:1664
    ds_read_b32 v118, v18 offset:1792
    ds_read_b32 v119, v18 offset:1920
    ds_read_b32 v120, v18 offset:2048
    ds_read_b32 v121, v18 offset:2176
    v_mov_b32 v16, 0
    v_mov_b32 v17, 0
    v_mov_b32 v18, 0
    v_mov_b32 v19, 0
    v_mov_b32 v20, 0
    v_mov_b32 v21, 0
    v_mov_b32 v22, 0
    v_mov_b32 v23, 0
    s_waitcnt lgkmcnt(0)
    s_waitcnt vmcnt(17)
    v_lshlrev_b32 v124, 16, v32
    v_and_b32 v125, 0xffff0000, v32
    v_fmac_f32 v16, v104, v124
    v_fmac_f32 v17, v104, v125
    v_lshlrev_b32 v124, 16, v33
    v_and_b32 v125, 0xffff0000, v33
    v_fmac_f32 v18, v104, v124
    v_fmac_f32 v19, v104, v125
    v_lshlrev_b32 v124, 16, v34
    v_and_b32 v125, 0xffff0000, v34
    v_fmac_f32 v20, v104, v124
    v_fmac_f32 v21, v104, v125
    v_lshlrev_b32 v124, 16, v35
    v_and_b32 v125, 0xffff0000, v35
    v_fmac_f32 v22, v104, v124
    v_fmac_f32 v23, v104, v125
    s_waitcnt vmcnt(16)
    v_lshlrev_b32 v124, 16, v36
    v_and_b32 v125, 0xffff0000, v36
    v_fmac_f32 v16, v105, v124
    v_fmac_f32 v17, v105, v125
    v_lshlrev_b32 v124, 16, v37
    v_and_b32 v125, 0xffff0000, v37
    v_fmac_f32 v18, v105, v124
    v_fmac_f32 v19, v105, v125
    v_lshlrev_b32 v124, 16, v38
    v_and_b32 v125, 0xffff0000, v38
    v_fmac_f32 v20, v105, v124
    v_fmac_f32 v21, v105, v125
    v_lshlrev_b32 v124, 16, v39
    v_and_b32 v125, 0xffff0000, v39
    v_fmac_f32 v22, v105, v124
    v_fmac_f32 v23, v105, v125
    s_waitcnt vmcnt(15)
    v_lshlrev_b32 v124, 16, v40
    v_and_b32 v125, 0xffff0000, v40
    v_fmac_f32 v16, v106, v124
    v_fmac_f32 v17, v106, v125
    v_lshlrev_b32 v124, 16, v41
    v_and_b32 v125, 0xffff0000, v41
    v_fmac_f32 v18, v106, v124
    v_fmac_f32 v19, v106, v125
    v_lshlrev_b32 v124, 16, v42
    v_and_b32 v125, 0xffff0000, v42
    v_fmac_f32 v20, v106, v124
    v_fmac_f32 v21, v106, v125
    v_lshlrev_b32 v124, 16, v43
    v_and_b32 v125, 0xffff0000, v43
    v_fmac_f32 v22, v106, v124
    v_fmac_f32 v23, v106, v125
    s_waitcnt vmcnt(14)
    v_lshlrev_b32 v124, 16, v44
    v_and_b32 v125, 0xffff0000, v44
    v_fmac_f32 v16, v107, v124
    v_fmac_f32 v17, v107, v125
    v_lshlrev_b32 v124, 16, v45
    v_and_b32 v125, 0xffff0000, v45
    v_fmac_f32 v18, v107, v124
    v_fmac_f32 v19, v107, v125
    v_lshlrev_b32 v124, 16, v46
    v_and_b32 v125, 0xffff0000, v46
    v_fmac_f32 v20, v107, v124
    v_fmac_f32 v21, v107, v125
    v_lshlrev_b32 v124, 16, v47
    v_and_b32 v125, 0xffff0000, v47
    v_fmac_f32 v22, v107, v124
    v_fmac_f32 v23, v107, v125
    s_waitcnt vmcnt(13)
    v_lshlrev_b32 v124, 16, v48
    v_and_b32 v125, 0xffff0000, v48
    v_fmac_f32 v16, v108, v124
    v_fmac_f32 v17, v108, v125
    v_lshlrev_b32 v124, 16, v49
    v_and_b32 v125, 0xffff0000, v49
    v_fmac_f32 v18, v108, v124
    v_fmac_f32 v19, v108, v125
    v_lshlrev_b32 v124, 16, v50
    v_and_b32 v125, 0xffff0000, v50
    v_fmac_f32 v20, v108, v124
    v_fmac_f32 v21, v108, v125
    v_lshlrev_b32 v124, 16, v51
    v_and_b32 v125, 0xffff0000, v51
    v_fmac_f32 v22, v108, v124
    v_fmac_f32 v23, v108, v125
    s_waitcnt vmcnt(12)
    v_lshlrev_b32 v124, 16, v52
    v_and_b32 v125, 0xffff0000, v52
    v_fmac_f32 v16, v109, v124
    v_fmac_f32 v17, v109, v125
    v_lshlrev_b32 v124, 16, v53
    v_and_b32 v125, 0xffff0000, v53
    v_fmac_f32 v18, v109, v124
    v_fmac_f32 v19, v109, v125
    v_lshlrev_b32 v124, 16, v54
    v_and_b32 v125, 0xffff0000, v54
    v_fmac_f32 v20, v109, v124
    v_fmac_f32 v21, v109, v125
    v_lshlrev_b32 v124, 16, v55
    v_and_b32 v125, 0xffff0000, v55
    v_fmac_f32 v22, v109, v124
    v_fmac_f32 v23, v109, v125
    s_waitcnt vmcnt(11)
    v_lshlrev_b32 v124, 16, v56
    v_and_b32 v125, 0xffff0000, v56
    v_fmac_f32 v16, v110, v124
    v_fmac_f32 v17, v110, v125
    v_lshlrev_b32 v124, 16, v57
    v_and_b32 v125, 0xffff0000, v57
    v_fmac_f32 v18, v110, v124
    v_fmac_f32 v19, v110, v125
    v_lshlrev_b32 v124, 16, v58
    v_and_b32 v125, 0xffff0000, v58
    v_fmac_f32 v20, v110, v124
    v_fmac_f32 v21, v110, v125
    v_lshlrev_b32 v124, 16, v59
    v_and_b32 v125, 0xffff0000, v59
    v_fmac_f32 v22, v110, v124
    v_fmac_f32 v23, v110, v125
    s_waitcnt vmcnt(10)
    v_lshlrev_b32 v124, 16, v60
    v_and_b32 v125, 0xffff0000, v60
    v_fmac_f32 v16, v111, v124
    v_fmac_f32 v17, v111, v125
    v_lshlrev_b32 v124, 16, v61
    v_and_b32 v125, 0xffff0000, v61
    v_fmac_f32 v18, v111, v124
    v_fmac_f32 v19, v111, v125
    v_lshlrev_b32 v124, 16, v62
    v_and_b32 v125, 0xffff0000, v62
    v_fmac_f32 v20, v111, v124
    v_fmac_f32 v21, v111, v125
    v_lshlrev_b32 v124, 16, v63
    v_and_b32 v125, 0xffff0000, v63
    v_fmac_f32 v22, v111, v124
    v_fmac_f32 v23, v111, v125
    s_waitcnt vmcnt(9)
    v_lshlrev_b32 v124, 16, v64
    v_and_b32 v125, 0xffff0000, v64
    v_fmac_f32 v16, v112, v124
    v_fmac_f32 v17, v112, v125
    v_lshlrev_b32 v124, 16, v65
    v_and_b32 v125, 0xffff0000, v65
    v_fmac_f32 v18, v112, v124
    v_fmac_f32 v19, v112, v125
    v_lshlrev_b32 v124, 16, v66
    v_and_b32 v125, 0xffff0000, v66
    v_fmac_f32 v20, v112, v124
    v_fmac_f32 v21, v112, v125
    v_lshlrev_b32 v124, 16, v67
    v_and_b32 v125, 0xffff0000, v67
    v_fmac_f32 v22, v112, v124
    v_fmac_f32 v23, v112, v125
    s_waitcnt vmcnt(8)
    v_lshlrev_b32 v124, 16, v68
    v_and_b32 v125, 0xffff0000, v68
    v_fmac_f32 v16, v113, v124
    v_fmac_f32 v17, v113, v125
    v_lshlrev_b32 v124, 16, v69
    v_and_b32 v125, 0xffff0000, v69
    v_fmac_f32 v18, v113, v124
    v_fmac_f32 v19, v113, v125
    v_lshlrev_b32 v124, 16, v70
    v_and_b32 v125, 0xffff0000, v70
    v_fmac_f32 v20, v113, v124
    v_fmac_f32 v21, v113, v125
    v_lshlrev_b32 v124, 16, v71
    v_and_b32 v125, 0xffff0000, v71
    v_fmac_f32 v22, v113, v124
    v_fmac_f32 v23, v113, v125
    s_waitcnt vmcnt(7)
    v_lshlrev_b32 v124, 16, v72
    v_and_b32 v125, 0xffff0000, v72
    v_fmac_f32 v16, v114, v124
    v_fmac_f32 v17, v114, v125
    v_lshlrev_b32 v124, 16, v73
    v_and_b32 v125, 0xffff0000, v73
    v_fmac_f32 v18, v114, v124
    v_fmac_f32 v19, v114, v125
    v_lshlrev_b32 v124, 16, v74
    v_and_b32 v125, 0xffff0000, v74
    v_fmac_f32 v20, v114, v124
    v_fmac_f32 v21, v114, v125
    v_lshlrev_b32 v124, 16, v75
    v_and_b32 v125, 0xffff0000, v75
    v_fmac_f32 v22, v114, v124
    v_fmac_f32 v23, v114, v125
    s_waitcnt vmcnt(6)
    v_lshlrev_b32 v124, 16, v76
    v_and_b32 v125, 0xffff0000, v76
    v_fmac_f32 v16, v115, v124
    v_fmac_f32 v17, v115, v125
    v_lshlrev_b32 v124, 16, v77
    v_and_b32 v125, 0xffff0000, v77
    v_fmac_f32 v18, v115, v124
    v_fmac_f32 v19, v115, v125
    v_lshlrev_b32 v124, 16, v78
    v_and_b32 v125, 0xffff0000, v78
    v_fmac_f32 v20, v115, v124
    v_fmac_f32 v21, v115, v125
    v_lshlrev_b32 v124, 16, v79
    v_and_b32 v125, 0xffff0000, v79
    v_fmac_f32 v22, v115, v124
    v_fmac_f32 v23, v115, v125
    s_waitcnt vmcnt(5)
    v_lshlrev_b32 v124, 16, v80
    v_and_b32 v125, 0xffff0000, v80
    v_fmac_f32 v16, v116, v124
    v_fmac_f32 v17, v116, v125
    v_lshlrev_b32 v124, 16, v81
    v_and_b32 v125, 0xffff0000, v81
    v_fmac_f32 v18, v116, v124
    v_fmac_f32 v19, v116, v125
    v_lshlrev_b32 v124, 16, v82
    v_and_b32 v125, 0xffff0000, v82
    v_fmac_f32 v20, v116, v124
    v_fmac_f32 v21, v116, v125
    v_lshlrev_b32 v124, 16, v83
    v_and_b32 v125, 0xffff0000, v83
    v_fmac_f32 v22, v116, v124
    v_fmac_f32 v23, v116, v125
    s_waitcnt vmcnt(4)
    v_lshlrev_b32 v124, 16, v84
    v_and_b32 v125, 0xffff0000, v84
    v_fmac_f32 v16, v117, v124
    v_fmac_f32 v17, v117, v125
    v_lshlrev_b32 v124, 16, v85
    v_and_b32 v125, 0xffff0000, v85
    v_fmac_f32 v18, v117, v124
    v_fmac_f32 v19, v117, v125
    v_lshlrev_b32 v124, 16, v86
    v_and_b32 v125, 0xffff0000, v86
    v_fmac_f32 v20, v117, v124
    v_fmac_f32 v21, v117, v125
    v_lshlrev_b32 v124, 16, v87
    v_and_b32 v125, 0xffff0000, v87
    v_fmac_f32 v22, v117, v124
    v_fmac_f32 v23, v117, v125
    s_waitcnt vmcnt(3)
    v_lshlrev_b32 v124, 16, v88
    v_and_b32 v125, 0xffff0000, v88
    v_fmac_f32 v16, v118, v124
    v_fmac_f32 v17, v118, v125
    v_lshlrev_b32 v124, 16, v89
    v_and_b32 v125, 0xffff0000, v89
    v_fmac_f32 v18, v118, v124
    v_fmac_f32 v19, v118, v125
    v_lshlrev_b32 v124, 16, v90
    v_and_b32 v125, 0xffff0000, v90
    v_fmac_f32 v20, v118, v124
    v_fmac_f32 v21, v118, v125
    v_lshlrev_b32 v124, 16, v91
    v_and_b32 v125, 0xffff0000, v91
    v_fmac_f32 v22, v118, v124
    v_fmac_f32 v23, v118, v125
    s_waitcnt vmcnt(2)
    v_lshlrev_b32 v124, 16, v92
    v_and_b32 v125, 0xffff0000, v92
    v_fmac_f32 v16, v119, v124
    v_fmac_f32 v17, v119, v125
    v_lshlrev_b32 v124, 16, v93
    v_and_b32 v125, 0xffff0000, v93
    v_fmac_f32 v18, v119, v124
    v_fmac_f32 v19, v119, v125
    v_lshlrev_b32 v124, 16, v94
    v_and_b32 v125, 0xffff0000, v94
    v_fmac_f32 v20, v119, v124
    v_fmac_f32 v21, v119, v125
    v_lshlrev_b32 v124, 16, v95
    v_and_b32 v125, 0xffff0000, v95
    v_fmac_f32 v22, v119, v124
    v_fmac_f32 v23, v119, v125
    s_waitcnt vmcnt(1)
    v_lshlrev_b32 v124, 16, v96
    v_and_b32 v125, 0xffff0000, v96
    v_fmac_f32 v16, v120, v124
    v_fmac_f32 v17, v120, v125
    v_lshlrev_b32 v124, 16, v97
    v_and_b32 v125, 0xffff0000, v97
    v_fmac_f32 v18, v120, v124
    v_fmac_f32 v19, v120, v125
    v_lshlrev_b32 v124, 16, v98
    v_and_b32 v125, 0xffff0000, v98
    v_fmac_f32 v20, v120, v124
    v_fmac_f32 v21, v120, v125
    v_lshlrev_b32 v124, 16, v99
    v_and_b32 v125, 0xffff0000, v99
    v_fmac_f32 v22, v120, v124
    v_fmac_f32 v23, v120, v125
    s_waitcnt vmcnt(0)
    v_lshlrev_b32 v124, 16, v100
    v_and_b32 v125, 0xffff0000, v100
    v_fmac_f32 v16, v121, v124
    v_fmac_f32 v17, v121, v125
    v_lshlrev_b32 v124, 16, v101
    v_and_b32 v125, 0xffff0000, v101
    v_fmac_f32 v18, v121, v124
    v_fmac_f32 v19, v121, v125
    v_lshlrev_b32 v124, 16, v102
    v_and_b32 v125, 0xffff0000, v102
    v_fmac_f32 v20, v121, v124
    v_fmac_f32 v21, v121, v125
    v_lshlrev_b32 v124, 16, v103
    v_and_b32 v125, 0xffff0000, v103
    v_fmac_f32 v22, v121, v124
    v_fmac_f32 v23, v121, v125
    v_lshlrev_b32 v26, 8, v2
    v_lshl_add_u32 v26, v1, 5, v26
    ds_write_b128 v26, v[16:19] offset:4096
    ds_write_b128 v26, v[20:23] offset:4112
    s_waitcnt lgkmcnt(0)
    s_barrier
    v_cmp_gt_u32 vcc, 64, v0
    s_and_saveexec_b64 s[26:27], vcc
    s_cbranch_execz K1_exit
    v_lshlrev_b32 v18, 2, v0
    ds_read_b32 v32, v18 offset:4096
    ds_read_b32 v33, v18 offset:4352
    ds_read_b32 v34, v18 offset:4608
    ds_read_b32 v35, v18 offset:4864
    ds_read_b32 v36, v18 offset:5120
    ds_read_b32 v37, v18 offset:5376
    ds_read_b32 v38, v18 offset:5632
    ds_read_b32 v39, v18 offset:5888
    ds_read_b32 v40, v18 offset:6144
    ds_read_b32 v41, v18 offset:6400
    ds_read_b32 v42, v18 offset:6656
    ds_read_b32 v43, v18 offset:6912
    ds_read_b32 v44, v18 offset:7168
    ds_read_b32 v45, v18 offset:7424
    ds_read_b32 v46, v18 offset:7680
    ds_read_b32 v47, v18 offset:7936
    ds_read_b32 v48, v18 offset:8192
    ds_read_b32 v49, v18 offset:8448
    ds_read_b32 v50, v18 offset:8704
    ds_read_b32 v51, v18 offset:8960
    ds_read_b32 v52, v18 offset:9216
    ds_read_b32 v53, v18 offset:9472
    ds_read_b32 v54, v18 offset:9728
    ds_read_b32 v55, v18 offset:9984
    ds_read_b32 v56, v18 offset:10240
    ds_read_b32 v57, v18 offset:10496
    ds_read_b32 v58, v18 offset:10752
    ds_read_b32 v59, v18 offset:11008
    ds_read_b32 v60, v18 offset:11264
    ds_read_b32 v61, v18 offset:11520
    ds_read_b32 v62, v18 offset:11776
    ds_read_b32 v63, v18 offset:12032
    s_waitcnt lgkmcnt(0)
    v_add_f32 v32, v32, v48
    v_add_f32 v33, v33, v49
    v_add_f32 v34, v34, v50
    v_add_f32 v35, v35, v51
    v_add_f32 v36, v36, v52
    v_add_f32 v37, v37, v53
    v_add_f32 v38, v38, v54
    v_add_f32 v39, v39, v55
    v_add_f32 v40, v40, v56
    v_add_f32 v41, v41, v57
    v_add_f32 v42, v42, v58
    v_add_f32 v43, v43, v59
    v_add_f32 v44, v44, v60
    v_add_f32 v45, v45, v61
    v_add_f32 v46, v46, v62
    v_add_f32 v47, v47, v63
    v_add_f32 v32, v32, v40
    v_add_f32 v33, v33, v41
    v_add_f32 v34, v34, v42
    v_add_f32 v35, v35, v43
    v_add_f32 v36, v36, v44
    v_add_f32 v37, v37, v45
    v_add_f32 v38, v38, v46
    v_add_f32 v39, v39, v47
    v_add_f32 v32, v32, v36
    v_add_f32 v33, v33, v37
    v_add_f32 v34, v34, v38
    v_add_f32 v35, v35, v39
    v_add_f32 v32, v32, v34
    v_add_f32 v33, v33, v35
    v_add_f32 v32, v32, v33
    v_cvt_pk_bf16_f32 v18, v32, v32
    s_cmp_ge_u32 s2, 64
    s_cbranch_scc1 K1_mlp_fin
    s_lshl_b32 s20, s2, 7
    v_lshlrev_b32 v19, 1, v0
    v_add_u32 v19, s20, v19
    global_store_short v19, v18, s[12:13] offset:0
    s_branch K1_exit
K1_mlp_fin:
    v_lshlrev_b32 v20, 16, v18
    v_add_u32 v19, 32, v0
    v_and_b32 v19, 63, v19
    v_lshlrev_b32 v19, 2, v19
    ds_bpermute_b32 v21, v19, v20
    s_waitcnt lgkmcnt(0)
    v_mul_f32 v22, v20, v20
    v_mul_f32 v22, 0x3d372713, v22
    v_fma_f32 v22, v22, v20, v20
    v_mul_f32 v22, 0x40135761, v22
    v_exp_f32 v22, v22
    s_nop 0
    v_add_f32 v22, 1.0, v22
    v_rcp_f32 v22, v22
    s_nop 0
    v_sub_f32 v22, 1.0, v22
    v_mul_f32 v22, v20, v22
    v_cvt_pk_bf16_f32 v22, v22, v22
    v_lshlrev_b32 v22, 16, v22
    v_mul_f32 v22, v22, v21
    v_cvt_pk_bf16_f32 v22, v22, v22
    v_lshlrev_b32 v22, 16, v22
    v_cmp_gt_u32 vcc, 32, v0
    s_and_b64 exec, exec, vcc
    s_cbranch_execz K1_exit
    s_sub_u32 s20, s2, 64
    s_lshl_b32 s20, s20, 7
    v_lshlrev_b32 v19, 2, v0
    v_add_u32 v19, s20, v19
    v_add_u32 v19, 16384, v19
    global_store_dword v19, v22, s[12:13]
    s_branch K1_exit
K1_exit:
    s_endpgm

.p2align 8
.type attn_kernel,@function
attn_kernel:
    s_cmp_ge_u32 s2, 1024
    s_cbranch_scc1 K2_exit
    s_load_dwordx4 s[4:7], s[0:1], 8
    s_load_dwordx2 s[8:9], s[0:1], 88
    v_lshrrev_b32 v1, 6, v0
    v_and_b32 v3, 63, v0
    s_nop 0
    v_readfirstlane_b32 s20, v1
    s_lshr_b32 s21, s2, 6
    s_and_b32 s22, s2, 63
    s_mul_i32 s23, s22, 4
    s_add_u32 s23, s23, s20
    s_mul_i32 s23, s23, 65536
    s_lshl_b32 s24, s21, 24
    s_add_u32 s23, s23, s24
    v_lshlrev_b32 v1, 4, v3
    v_add_u32 v2, 4096, v1
    v_and_b32 v113, 15, v3
    v_lshlrev_b32 v113, 4, v113
    s_lshl_b32 s25, s21, 9
    v_add_u32 v113, s25, v113
    s_waitcnt lgkmcnt(0)
    s_add_u32 s12, s4, s23
    s_addc_u32 s13, s5, 0
    s_mov_b32 s14, 65536
    s_mov_b32 s15, 0x00020000
    s_add_u32 s16, s6, s23
    s_addc_u32 s17, s7, 0
    s_mov_b32 s18, 65536
    s_mov_b32 s19, 0x00020000
    buffer_load_dwordx4 v[48:51], v1, s[12:15], 0 offen offset:0 nt
    buffer_load_dwordx4 v[52:55], v1, s[12:15], 0 offen offset:1024 nt
    buffer_load_dwordx4 v[56:59], v1, s[12:15], 0 offen offset:2048 nt
    buffer_load_dwordx4 v[60:63], v1, s[12:15], 0 offen offset:3072 nt
    buffer_load_dwordx4 v[64:67], v2, s[12:15], 0 offen offset:0 nt
    buffer_load_dwordx4 v[68:71], v2, s[12:15], 0 offen offset:1024 nt
    buffer_load_dwordx4 v[72:75], v2, s[12:15], 0 offen offset:2048 nt
    buffer_load_dwordx4 v[76:79], v2, s[12:15], 0 offen offset:3072 nt
    buffer_load_dwordx4 v[80:83], v1, s[16:19], 0 offen offset:0 nt
    buffer_load_dwordx4 v[84:87], v1, s[16:19], 0 offen offset:1024 nt
    buffer_load_dwordx4 v[88:91], v1, s[16:19], 0 offen offset:2048 nt
    buffer_load_dwordx4 v[92:95], v1, s[16:19], 0 offen offset:3072 nt
    buffer_load_dwordx4 v[96:99], v2, s[16:19], 0 offen offset:0 nt
    buffer_load_dwordx4 v[100:103], v2, s[16:19], 0 offen offset:1024 nt
    buffer_load_dwordx4 v[104:107], v2, s[16:19], 0 offen offset:2048 nt
    buffer_load_dwordx4 v[108:111], v2, s[16:19], 0 offen offset:3072 nt
    global_load_dwordx4 v[4:7], v113, s[8:9] offset:0
    global_load_dwordx4 v[8:11], v113, s[8:9] offset:256
    v_mov_b32 v12, 0xf149f2ca
    v_mov_b32 v13, 0xf149f2ca
    v_mov_b32 v14, 0
    v_mov_b32 v15, 0
    v_mov_b32 v16, 0
    v_mov_b32 v17, 0
    v_mov_b32 v18, 0
    v_mov_b32 v19, 0
    v_mov_b32 v20, 0
    v_mov_b32 v21, 0
    v_mov_b32 v22, 0
    v_mov_b32 v23, 0
    v_mov_b32 v24, 0
    v_mov_b32 v25, 0
    v_mov_b32 v26, 0
    v_mov_b32 v27, 0
    v_mov_b32 v28, 0
    v_mov_b32 v29, 0
    v_mov_b32 v30, 0
    v_mov_b32 v31, 0
    s_mov_b32 s26, 0x3e0293ee
    s_mov_b32 s27, 0
    s_mov_b32 s28, 0
    s_waitcnt vmcnt(0)
K2_loop:
    s_waitcnt vmcnt(8)
    v_dot2_f32_bf16 v32, v48, v4, 0
    v_dot2_f32_bf16 v40, v48, v8, 0
    v_dot2_f32_bf16 v33, v52, v4, 0
    v_dot2_f32_bf16 v41, v52, v8, 0
    v_dot2_f32_bf16 v34, v56, v4, 0
    v_dot2_f32_bf16 v42, v56, v8, 0
    v_dot2_f32_bf16 v35, v60, v4, 0
    v_dot2_f32_bf16 v43, v60, v8, 0
    v_dot2_f32_bf16 v36, v64, v4, 0
    v_dot2_f32_bf16 v44, v64, v8, 0
    v_dot2_f32_bf16 v37, v68, v4, 0
    v_dot2_f32_bf16 v45, v68, v8, 0
    v_dot2_f32_bf16 v38, v72, v4, 0
    v_dot2_f32_bf16 v46, v72, v8, 0
    v_dot2_f32_bf16 v39, v76, v4, 0
    v_dot2_f32_bf16 v47, v76, v8, 0
    v_dot2_f32_bf16 v32, v49, v5, v32
    v_dot2_f32_bf16 v40, v49, v9, v40
    v_dot2_f32_bf16 v33, v53, v5, v33
    v_dot2_f32_bf16 v41, v53, v9, v41
    v_dot2_f32_bf16 v34, v57, v5, v34
    v_dot2_f32_bf16 v42, v57, v9, v42
    v_dot2_f32_bf16 v35, v61, v5, v35
    v_dot2_f32_bf16 v43, v61, v9, v43
    v_dot2_f32_bf16 v36, v65, v5, v36
    v_dot2_f32_bf16 v44, v65, v9, v44
    v_dot2_f32_bf16 v37, v69, v5, v37
    v_dot2_f32_bf16 v45, v69, v9, v45
    v_dot2_f32_bf16 v38, v73, v5, v38
    v_dot2_f32_bf16 v46, v73, v9, v46
    v_dot2_f32_bf16 v39, v77, v5, v39
    v_dot2_f32_bf16 v47, v77, v9, v47
    v_dot2_f32_bf16 v32, v50, v6, v32
    v_dot2_f32_bf16 v40, v50, v10, v40
    v_dot2_f32_bf16 v33, v54, v6, v33
    v_dot2_f32_bf16 v41, v54, v10, v41
    v_dot2_f32_bf16 v34, v58, v6, v34
    v_dot2_f32_bf16 v42, v58, v10, v42
    v_dot2_f32_bf16 v35, v62, v6, v35
    v_dot2_f32_bf16 v43, v62, v10, v43
    v_dot2_f32_bf16 v36, v66, v6, v36
    v_dot2_f32_bf16 v44, v66, v10, v44
    v_dot2_f32_bf16 v37, v70, v6, v37
    v_dot2_f32_bf16 v45, v70, v10, v45
    v_dot2_f32_bf16 v38, v74, v6, v38
    v_dot2_f32_bf16 v46, v74, v10, v46
    v_dot2_f32_bf16 v39, v78, v6, v39
    v_dot2_f32_bf16 v47, v78, v10, v47
    v_dot2_f32_bf16 v32, v51, v7, v32
    v_dot2_f32_bf16 v40, v51, v11, v40
    v_dot2_f32_bf16 v33, v55, v7, v33
    v_dot2_f32_bf16 v41, v55, v11, v41
    v_dot2_f32_bf16 v34, v59, v7, v34
    v_dot2_f32_bf16 v42, v59, v11, v42
    v_dot2_f32_bf16 v35, v63, v7, v35
    v_dot2_f32_bf16 v43, v63, v11, v43
    v_dot2_f32_bf16 v36, v67, v7, v36
    v_dot2_f32_bf16 v44, v67, v11, v44
    v_dot2_f32_bf16 v37, v71, v7, v37
    v_dot2_f32_bf16 v45, v71, v11, v45
    v_dot2_f32_bf16 v38, v75, v7, v38
    v_dot2_f32_bf16 v46, v75, v11, v46
    v_dot2_f32_bf16 v39, v79, v7, v39
    v_dot2_f32_bf16 v47, v79, v11, v47
    s_add_u32 s27, s27, 8192
    buffer_load_dwordx4 v[48:51], v1, s[12:15], s27 offen offset:0 nt
    buffer_load_dwordx4 v[52:55], v1, s[12:15], s27 offen offset:1024 nt
    buffer_load_dwordx4 v[56:59], v1, s[12:15], s27 offen offset:2048 nt
    buffer_load_dwordx4 v[60:63], v1, s[12:15], s27 offen offset:3072 nt
    buffer_load_dwordx4 v[64:67], v2, s[12:15], s27 offen offset:0 nt
    buffer_load_dwordx4 v[68:71], v2, s[12:15], s27 offen offset:1024 nt
    buffer_load_dwordx4 v[72:75], v2, s[12:15], s27 offen offset:2048 nt
    buffer_load_dwordx4 v[76:79], v2, s[12:15], s27 offen offset:3072 nt
    v_add_f32_dpp v32, v32, v32 quad_perm:[1,0,3,2] row_mask:0xf bank_mask:0xf
    v_add_f32_dpp v33, v33, v33 quad_perm:[1,0,3,2] row_mask:0xf bank_mask:0xf
    v_add_f32_dpp v34, v34, v34 quad_perm:[1,0,3,2] row_mask:0xf bank_mask:0xf
    v_add_f32_dpp v35, v35, v35 quad_perm:[1,0,3,2] row_mask:0xf bank_mask:0xf
    v_add_f32_dpp v36, v36, v36 quad_perm:[1,0,3,2] row_mask:0xf bank_mask:0xf
    v_add_f32_dpp v37, v37, v37 quad_perm:[1,0,3,2] row_mask:0xf bank_mask:0xf
    v_add_f32_dpp v38, v38, v38 quad_perm:[1,0,3,2] row_mask:0xf bank_mask:0xf
    v_add_f32_dpp v39, v39, v39 quad_perm:[1,0,3,2] row_mask:0xf bank_mask:0xf
    v_add_f32_dpp v40, v40, v40 quad_perm:[1,0,3,2] row_mask:0xf bank_mask:0xf
    v_add_f32_dpp v41, v41, v41 quad_perm:[1,0,3,2] row_mask:0xf bank_mask:0xf
    v_add_f32_dpp v42, v42, v42 quad_perm:[1,0,3,2] row_mask:0xf bank_mask:0xf
    v_add_f32_dpp v43, v43, v43 quad_perm:[1,0,3,2] row_mask:0xf bank_mask:0xf
    v_add_f32_dpp v44, v44, v44 quad_perm:[1,0,3,2] row_mask:0xf bank_mask:0xf
    v_add_f32_dpp v45, v45, v45 quad_perm:[1,0,3,2] row_mask:0xf bank_mask:0xf
    v_add_f32_dpp v46, v46, v46 quad_perm:[1,0,3,2] row_mask:0xf bank_mask:0xf
    v_add_f32_dpp v47, v47, v47 quad_perm:[1,0,3,2] row_mask:0xf bank_mask:0xf
    v_add_f32_dpp v32, v32, v32 quad_perm:[2,3,0,1] row_mask:0xf bank_mask:0xf
    v_add_f32_dpp v33, v33, v33 quad_perm:[2,3,0,1] row_mask:0xf bank_mask:0xf
    v_add_f32_dpp v34, v34, v34 quad_perm:[2,3,0,1] row_mask:0xf bank_mask:0xf
    v_add_f32_dpp v35, v35, v35 quad_perm:[2,3,0,1] row_mask:0xf bank_mask:0xf
    v_add_f32_dpp v36, v36, v36 quad_perm:[2,3,0,1] row_mask:0xf bank_mask:0xf
    v_add_f32_dpp v37, v37, v37 quad_perm:[2,3,0,1] row_mask:0xf bank_mask:0xf
    v_add_f32_dpp v38, v38, v38 quad_perm:[2,3,0,1] row_mask:0xf bank_mask:0xf
    v_add_f32_dpp v39, v39, v39 quad_perm:[2,3,0,1] row_mask:0xf bank_mask:0xf
    v_add_f32_dpp v40, v40, v40 quad_perm:[2,3,0,1] row_mask:0xf bank_mask:0xf
    v_add_f32_dpp v41, v41, v41 quad_perm:[2,3,0,1] row_mask:0xf bank_mask:0xf
    v_add_f32_dpp v42, v42, v42 quad_perm:[2,3,0,1] row_mask:0xf bank_mask:0xf
    v_add_f32_dpp v43, v43, v43 quad_perm:[2,3,0,1] row_mask:0xf bank_mask:0xf
    v_add_f32_dpp v44, v44, v44 quad_perm:[2,3,0,1] row_mask:0xf bank_mask:0xf
    v_add_f32_dpp v45, v45, v45 quad_perm:[2,3,0,1] row_mask:0xf bank_mask:0xf
    v_add_f32_dpp v46, v46, v46 quad_perm:[2,3,0,1] row_mask:0xf bank_mask:0xf
    v_add_f32_dpp v47, v47, v47 quad_perm:[2,3,0,1] row_mask:0xf bank_mask:0xf
    v_add_f32_dpp v32, v32, v32 row_half_mirror row_mask:0xf bank_mask:0xf
    v_add_f32_dpp v33, v33, v33 row_half_mirror row_mask:0xf bank_mask:0xf
    v_add_f32_dpp v34, v34, v34 row_half_mirror row_mask:0xf bank_mask:0xf
    v_add_f32_dpp v35, v35, v35 row_half_mirror row_mask:0xf bank_mask:0xf
    v_add_f32_dpp v36, v36, v36 row_half_mirror row_mask:0xf bank_mask:0xf
    v_add_f32_dpp v37, v37, v37 row_half_mirror row_mask:0xf bank_mask:0xf
    v_add_f32_dpp v38, v38, v38 row_half_mirror row_mask:0xf bank_mask:0xf
    v_add_f32_dpp v39, v39, v39 row_half_mirror row_mask:0xf bank_mask:0xf
    v_add_f32_dpp v40, v40, v40 row_half_mirror row_mask:0xf bank_mask:0xf
    v_add_f32_dpp v41, v41, v41 row_half_mirror row_mask:0xf bank_mask:0xf
    v_add_f32_dpp v42, v42, v42 row_half_mirror row_mask:0xf bank_mask:0xf
    v_add_f32_dpp v43, v43, v43 row_half_mirror row_mask:0xf bank_mask:0xf
    v_add_f32_dpp v44, v44, v44 row_half_mirror row_mask:0xf bank_mask:0xf
    v_add_f32_dpp v45, v45, v45 row_half_mirror row_mask:0xf bank_mask:0xf
    v_add_f32_dpp v46, v46, v46 row_half_mirror row_mask:0xf bank_mask:0xf
    v_add_f32_dpp v47, v47, v47 row_half_mirror row_mask:0xf bank_mask:0xf
    v_add_f32_dpp v32, v32, v32 row_mirror row_mask:0xf bank_mask:0xf
    v_add_f32_dpp v33, v33, v33 row_mirror row_mask:0xf bank_mask:0xf
    v_add_f32_dpp v34, v34, v34 row_mirror row_mask:0xf bank_mask:0xf
    v_add_f32_dpp v35, v35, v35 row_mirror row_mask:0xf bank_mask:0xf
    v_add_f32_dpp v36, v36, v36 row_mirror row_mask:0xf bank_mask:0xf
    v_add_f32_dpp v37, v37, v37 row_mirror row_mask:0xf bank_mask:0xf
    v_add_f32_dpp v38, v38, v38 row_mirror row_mask:0xf bank_mask:0xf
    v_add_f32_dpp v39, v39, v39 row_mirror row_mask:0xf bank_mask:0xf
    v_add_f32_dpp v40, v40, v40 row_mirror row_mask:0xf bank_mask:0xf
    v_add_f32_dpp v41, v41, v41 row_mirror row_mask:0xf bank_mask:0xf
    v_add_f32_dpp v42, v42, v42 row_mirror row_mask:0xf bank_mask:0xf
    v_add_f32_dpp v43, v43, v43 row_mirror row_mask:0xf bank_mask:0xf
    v_add_f32_dpp v44, v44, v44 row_mirror row_mask:0xf bank_mask:0xf
    v_add_f32_dpp v45, v45, v45 row_mirror row_mask:0xf bank_mask:0xf
    v_add_f32_dpp v46, v46, v46 row_mirror row_mask:0xf bank_mask:0xf
    v_add_f32_dpp v47, v47, v47 row_mirror row_mask:0xf bank_mask:0xf
    v_max3_f32 v112, v32, v33, v34
    v_max3_f32 v112, v112, v35, v36
    v_max3_f32 v112, v112, v37, v38
    v_max3_f32 v112, v112, v39, v12
    v_max3_f32 v113, v40, v41, v42
    v_max3_f32 v113, v113, v43, v44
    v_max3_f32 v113, v113, v45, v46
    v_max3_f32 v113, v113, v47, v13
    v_sub_f32 v114, v12, v112
    v_mul_f32 v114, s26, v114
    v_mul_f32 v116, s26, v112
    v_exp_f32 v114, v114
    v_mov_b32 v12, v112
    v_sub_f32 v115, v13, v113
    v_mul_f32 v115, s26, v115
    v_mul_f32 v117, s26, v113
    v_exp_f32 v115, v115
    v_mov_b32 v13, v113
    v_fma_f32 v32, v32, s26, -v116
    v_fma_f32 v33, v33, s26, -v116
    v_fma_f32 v34, v34, s26, -v116
    v_fma_f32 v35, v35, s26, -v116
    v_fma_f32 v36, v36, s26, -v116
    v_fma_f32 v37, v37, s26, -v116
    v_fma_f32 v38, v38, s26, -v116
    v_fma_f32 v39, v39, s26, -v116
    v_fma_f32 v40, v40, s26, -v117
    v_fma_f32 v41, v41, s26, -v117
    v_fma_f32 v42, v42, s26, -v117
    v_fma_f32 v43, v43, s26, -v117
    v_fma_f32 v44, v44, s26, -v117
    v_fma_f32 v45, v45, s26, -v117
    v_fma_f32 v46, v46, s26, -v117
    v_fma_f32 v47, v47, s26, -v117
    v_exp_f32 v32, v32
    v_exp_f32 v33, v33
    v_exp_f32 v34, v34
    v_exp_f32 v35, v35
    v_exp_f32 v36, v36
    v_exp_f32 v37, v37
    v_exp_f32 v38, v38
    v_exp_f32 v39, v39
    v_exp_f32 v40, v40
    v_exp_f32 v41, v41
    v_exp_f32 v42, v42
    v_exp_f32 v43, v43
    v_exp_f32 v44, v44
    v_exp_f32 v45, v45
    v_exp_f32 v46, v46
    v_exp_f32 v47, v47
    v_fma_f32 v14, v14, v114, v32
    v_add_f32 v14, v14, v33
    v_add_f32 v14, v14, v34
    v_add_f32 v14, v14, v35
    v_add_f32 v14, v14, v36
    v_add_f32 v14, v14, v37
    v_add_f32 v14, v14, v38
    v_add_f32 v14, v14, v39
    v_mul_f32 v16, v114, v16
    v_mul_f32 v17, v114, v17
    v_mul_f32 v18, v114, v18
    v_mul_f32 v19, v114, v19
    v_mul_f32 v20, v114, v20
    v_mul_f32 v21, v114, v21
    v_mul_f32 v22, v114, v22
    v_mul_f32 v23, v114, v23
    v_fma_f32 v15, v15, v115, v40
    v_add_f32 v15, v15, v41
    v_add_f32 v15, v15, v42
    v_add_f32 v15, v15, v43
    v_add_f32 v15, v15, v44
    v_add_f32 v15, v15, v45
    v_add_f32 v15, v15, v46
    v_add_f32 v15, v15, v47
    v_mul_f32 v24, v115, v24
    v_mul_f32 v25, v115, v25
    v_mul_f32 v26, v115, v26
    v_mul_f32 v27, v115, v27
    v_mul_f32 v28, v115, v28
    v_mul_f32 v29, v115, v29
    v_mul_f32 v30, v115, v30
    v_mul_f32 v31, v115, v31
    s_waitcnt vmcnt(8)
    v_lshlrev_b32 v118, 16, v80
    v_and_b32 v119, 0xffff0000, v80
    v_fmac_f32 v16, v32, v118
    v_fmac_f32 v17, v32, v119
    v_fmac_f32 v24, v40, v118
    v_fmac_f32 v25, v40, v119
    v_lshlrev_b32 v120, 16, v81
    v_and_b32 v121, 0xffff0000, v81
    v_fmac_f32 v18, v32, v120
    v_fmac_f32 v19, v32, v121
    v_fmac_f32 v26, v40, v120
    v_fmac_f32 v27, v40, v121
    v_lshlrev_b32 v118, 16, v82
    v_and_b32 v119, 0xffff0000, v82
    v_fmac_f32 v20, v32, v118
    v_fmac_f32 v21, v32, v119
    v_fmac_f32 v28, v40, v118
    v_fmac_f32 v29, v40, v119
    v_lshlrev_b32 v120, 16, v83
    v_and_b32 v121, 0xffff0000, v83
    v_fmac_f32 v22, v32, v120
    v_fmac_f32 v23, v32, v121
    v_fmac_f32 v30, v40, v120
    v_fmac_f32 v31, v40, v121
    v_lshlrev_b32 v118, 16, v84
    v_and_b32 v119, 0xffff0000, v84
    v_fmac_f32 v16, v33, v118
    v_fmac_f32 v17, v33, v119
    v_fmac_f32 v24, v41, v118
    v_fmac_f32 v25, v41, v119
    v_lshlrev_b32 v120, 16, v85
    v_and_b32 v121, 0xffff0000, v85
    v_fmac_f32 v18, v33, v120
    v_fmac_f32 v19, v33, v121
    v_fmac_f32 v26, v41, v120
    v_fmac_f32 v27, v41, v121
    v_lshlrev_b32 v118, 16, v86
    v_and_b32 v119, 0xffff0000, v86
    v_fmac_f32 v20, v33, v118
    v_fmac_f32 v21, v33, v119
    v_fmac_f32 v28, v41, v118
    v_fmac_f32 v29, v41, v119
    v_lshlrev_b32 v120, 16, v87
    v_and_b32 v121, 0xffff0000, v87
    v_fmac_f32 v22, v33, v120
    v_fmac_f32 v23, v33, v121
    v_fmac_f32 v30, v41, v120
    v_fmac_f32 v31, v41, v121
    v_lshlrev_b32 v118, 16, v88
    v_and_b32 v119, 0xffff0000, v88
    v_fmac_f32 v16, v34, v118
    v_fmac_f32 v17, v34, v119
    v_fmac_f32 v24, v42, v118
    v_fmac_f32 v25, v42, v119
    v_lshlrev_b32 v120, 16, v89
    v_and_b32 v121, 0xffff0000, v89
    v_fmac_f32 v18, v34, v120
    v_fmac_f32 v19, v34, v121
    v_fmac_f32 v26, v42, v120
    v_fmac_f32 v27, v42, v121
    v_lshlrev_b32 v118, 16, v90
    v_and_b32 v119, 0xffff0000, v90
    v_fmac_f32 v20, v34, v118
    v_fmac_f32 v21, v34, v119
    v_fmac_f32 v28, v42, v118
    v_fmac_f32 v29, v42, v119
    v_lshlrev_b32 v120, 16, v91
    v_and_b32 v121, 0xffff0000, v91
    v_fmac_f32 v22, v34, v120
    v_fmac_f32 v23, v34, v121
    v_fmac_f32 v30, v42, v120
    v_fmac_f32 v31, v42, v121
    v_lshlrev_b32 v118, 16, v92
    v_and_b32 v119, 0xffff0000, v92
    v_fmac_f32 v16, v35, v118
    v_fmac_f32 v17, v35, v119
    v_fmac_f32 v24, v43, v118
    v_fmac_f32 v25, v43, v119
    v_lshlrev_b32 v120, 16, v93
    v_and_b32 v121, 0xffff0000, v93
    v_fmac_f32 v18, v35, v120
    v_fmac_f32 v19, v35, v121
    v_fmac_f32 v26, v43, v120
    v_fmac_f32 v27, v43, v121
    v_lshlrev_b32 v118, 16, v94
    v_and_b32 v119, 0xffff0000, v94
    v_fmac_f32 v20, v35, v118
    v_fmac_f32 v21, v35, v119
    v_fmac_f32 v28, v43, v118
    v_fmac_f32 v29, v43, v119
    v_lshlrev_b32 v120, 16, v95
    v_and_b32 v121, 0xffff0000, v95
    v_fmac_f32 v22, v35, v120
    v_fmac_f32 v23, v35, v121
    v_fmac_f32 v30, v43, v120
    v_fmac_f32 v31, v43, v121
    v_lshlrev_b32 v118, 16, v96
    v_and_b32 v119, 0xffff0000, v96
    v_fmac_f32 v16, v36, v118
    v_fmac_f32 v17, v36, v119
    v_fmac_f32 v24, v44, v118
    v_fmac_f32 v25, v44, v119
    v_lshlrev_b32 v120, 16, v97
    v_and_b32 v121, 0xffff0000, v97
    v_fmac_f32 v18, v36, v120
    v_fmac_f32 v19, v36, v121
    v_fmac_f32 v26, v44, v120
    v_fmac_f32 v27, v44, v121
    v_lshlrev_b32 v118, 16, v98
    v_and_b32 v119, 0xffff0000, v98
    v_fmac_f32 v20, v36, v118
    v_fmac_f32 v21, v36, v119
    v_fmac_f32 v28, v44, v118
    v_fmac_f32 v29, v44, v119
    v_lshlrev_b32 v120, 16, v99
    v_and_b32 v121, 0xffff0000, v99
    v_fmac_f32 v22, v36, v120
    v_fmac_f32 v23, v36, v121
    v_fmac_f32 v30, v44, v120
    v_fmac_f32 v31, v44, v121
    v_lshlrev_b32 v118, 16, v100
    v_and_b32 v119, 0xffff0000, v100
    v_fmac_f32 v16, v37, v118
    v_fmac_f32 v17, v37, v119
    v_fmac_f32 v24, v45, v118
    v_fmac_f32 v25, v45, v119
    v_lshlrev_b32 v120, 16, v101
    v_and_b32 v121, 0xffff0000, v101
    v_fmac_f32 v18, v37, v120
    v_fmac_f32 v19, v37, v121
    v_fmac_f32 v26, v45, v120
    v_fmac_f32 v27, v45, v121
    v_lshlrev_b32 v118, 16, v102
    v_and_b32 v119, 0xffff0000, v102
    v_fmac_f32 v20, v37, v118
    v_fmac_f32 v21, v37, v119
    v_fmac_f32 v28, v45, v118
    v_fmac_f32 v29, v45, v119
    v_lshlrev_b32 v120, 16, v103
    v_and_b32 v121, 0xffff0000, v103
    v_fmac_f32 v22, v37, v120
    v_fmac_f32 v23, v37, v121
    v_fmac_f32 v30, v45, v120
    v_fmac_f32 v31, v45, v121
    v_lshlrev_b32 v118, 16, v104
    v_and_b32 v119, 0xffff0000, v104
    v_fmac_f32 v16, v38, v118
    v_fmac_f32 v17, v38, v119
    v_fmac_f32 v24, v46, v118
    v_fmac_f32 v25, v46, v119
    v_lshlrev_b32 v120, 16, v105
    v_and_b32 v121, 0xffff0000, v105
    v_fmac_f32 v18, v38, v120
    v_fmac_f32 v19, v38, v121
    v_fmac_f32 v26, v46, v120
    v_fmac_f32 v27, v46, v121
    v_lshlrev_b32 v118, 16, v106
    v_and_b32 v119, 0xffff0000, v106
    v_fmac_f32 v20, v38, v118
    v_fmac_f32 v21, v38, v119
    v_fmac_f32 v28, v46, v118
    v_fmac_f32 v29, v46, v119
    v_lshlrev_b32 v120, 16, v107
    v_and_b32 v121, 0xffff0000, v107
    v_fmac_f32 v22, v38, v120
    v_fmac_f32 v23, v38, v121
    v_fmac_f32 v30, v46, v120
    v_fmac_f32 v31, v46, v121
    v_lshlrev_b32 v118, 16, v108
    v_and_b32 v119, 0xffff0000, v108
    v_fmac_f32 v16, v39, v118
    v_fmac_f32 v17, v39, v119
    v_fmac_f32 v24, v47, v118
    v_fmac_f32 v25, v47, v119
    v_lshlrev_b32 v120, 16, v109
    v_and_b32 v121, 0xffff0000, v109
    v_fmac_f32 v18, v39, v120
    v_fmac_f32 v19, v39, v121
    v_fmac_f32 v26, v47, v120
    v_fmac_f32 v27, v47, v121
    v_lshlrev_b32 v118, 16, v110
    v_and_b32 v119, 0xffff0000, v110
    v_fmac_f32 v20, v39, v118
    v_fmac_f32 v21, v39, v119
    v_fmac_f32 v28, v47, v118
    v_fmac_f32 v29, v47, v119
    v_lshlrev_b32 v120, 16, v111
    v_and_b32 v121, 0xffff0000, v111
    v_fmac_f32 v22, v39, v120
    v_fmac_f32 v23, v39, v121
    v_fmac_f32 v30, v47, v120
    v_fmac_f32 v31, v47, v121
    buffer_load_dwordx4 v[80:83], v1, s[16:19], s27 offen offset:0 nt
    buffer_load_dwordx4 v[84:87], v1, s[16:19], s27 offen offset:1024 nt
    buffer_load_dwordx4 v[88:91], v1, s[16:19], s27 offen offset:2048 nt
    buffer_load_dwordx4 v[92:95], v1, s[16:19], s27 offen offset:3072 nt
    buffer_load_dwordx4 v[96:99], v2, s[16:19], s27 offen offset:0 nt
    buffer_load_dwordx4 v[100:103], v2, s[16:19], s27 offen offset:1024 nt
    buffer_load_dwordx4 v[104:107], v2, s[16:19], s27 offen offset:2048 nt
    buffer_load_dwordx4 v[108:111], v2, s[16:19], s27 offen offset:3072 nt
    s_add_u32 s28, s28, 1
    s_cmp_lt_u32 s28, 7
    s_cbranch_scc1 K2_loop
    s_waitcnt vmcnt(8)
    v_dot2_f32_bf16 v32, v48, v4, 0
    v_dot2_f32_bf16 v40, v48, v8, 0
    v_dot2_f32_bf16 v33, v52, v4, 0
    v_dot2_f32_bf16 v41, v52, v8, 0
    v_dot2_f32_bf16 v34, v56, v4, 0
    v_dot2_f32_bf16 v42, v56, v8, 0
    v_dot2_f32_bf16 v35, v60, v4, 0
    v_dot2_f32_bf16 v43, v60, v8, 0
    v_dot2_f32_bf16 v36, v64, v4, 0
    v_dot2_f32_bf16 v44, v64, v8, 0
    v_dot2_f32_bf16 v37, v68, v4, 0
    v_dot2_f32_bf16 v45, v68, v8, 0
    v_dot2_f32_bf16 v38, v72, v4, 0
    v_dot2_f32_bf16 v46, v72, v8, 0
    v_dot2_f32_bf16 v39, v76, v4, 0
    v_dot2_f32_bf16 v47, v76, v8, 0
    v_dot2_f32_bf16 v32, v49, v5, v32
    v_dot2_f32_bf16 v40, v49, v9, v40
    v_dot2_f32_bf16 v33, v53, v5, v33
    v_dot2_f32_bf16 v41, v53, v9, v41
    v_dot2_f32_bf16 v34, v57, v5, v34
    v_dot2_f32_bf16 v42, v57, v9, v42
    v_dot2_f32_bf16 v35, v61, v5, v35
    v_dot2_f32_bf16 v43, v61, v9, v43
    v_dot2_f32_bf16 v36, v65, v5, v36
    v_dot2_f32_bf16 v44, v65, v9, v44
    v_dot2_f32_bf16 v37, v69, v5, v37
    v_dot2_f32_bf16 v45, v69, v9, v45
    v_dot2_f32_bf16 v38, v73, v5, v38
    v_dot2_f32_bf16 v46, v73, v9, v46
    v_dot2_f32_bf16 v39, v77, v5, v39
    v_dot2_f32_bf16 v47, v77, v9, v47
    v_dot2_f32_bf16 v32, v50, v6, v32
    v_dot2_f32_bf16 v40, v50, v10, v40
    v_dot2_f32_bf16 v33, v54, v6, v33
    v_dot2_f32_bf16 v41, v54, v10, v41
    v_dot2_f32_bf16 v34, v58, v6, v34
    v_dot2_f32_bf16 v42, v58, v10, v42
    v_dot2_f32_bf16 v35, v62, v6, v35
    v_dot2_f32_bf16 v43, v62, v10, v43
    v_dot2_f32_bf16 v36, v66, v6, v36
    v_dot2_f32_bf16 v44, v66, v10, v44
    v_dot2_f32_bf16 v37, v70, v6, v37
    v_dot2_f32_bf16 v45, v70, v10, v45
    v_dot2_f32_bf16 v38, v74, v6, v38
    v_dot2_f32_bf16 v46, v74, v10, v46
    v_dot2_f32_bf16 v39, v78, v6, v39
    v_dot2_f32_bf16 v47, v78, v10, v47
    v_dot2_f32_bf16 v32, v51, v7, v32
    v_dot2_f32_bf16 v40, v51, v11, v40
    v_dot2_f32_bf16 v33, v55, v7, v33
    v_dot2_f32_bf16 v41, v55, v11, v41
    v_dot2_f32_bf16 v34, v59, v7, v34
    v_dot2_f32_bf16 v42, v59, v11, v42
    v_dot2_f32_bf16 v35, v63, v7, v35
    v_dot2_f32_bf16 v43, v63, v11, v43
    v_dot2_f32_bf16 v36, v67, v7, v36
    v_dot2_f32_bf16 v44, v67, v11, v44
    v_dot2_f32_bf16 v37, v71, v7, v37
    v_dot2_f32_bf16 v45, v71, v11, v45
    v_dot2_f32_bf16 v38, v75, v7, v38
    v_dot2_f32_bf16 v46, v75, v11, v46
    v_dot2_f32_bf16 v39, v79, v7, v39
    v_dot2_f32_bf16 v47, v79, v11, v47
    v_add_f32_dpp v32, v32, v32 quad_perm:[1,0,3,2] row_mask:0xf bank_mask:0xf
    v_add_f32_dpp v33, v33, v33 quad_perm:[1,0,3,2] row_mask:0xf bank_mask:0xf
    v_add_f32_dpp v34, v34, v34 quad_perm:[1,0,3,2] row_mask:0xf bank_mask:0xf
    v_add_f32_dpp v35, v35, v35 quad_perm:[1,0,3,2] row_mask:0xf bank_mask:0xf
    v_add_f32_dpp v36, v36, v36 quad_perm:[1,0,3,2] row_mask:0xf bank_mask:0xf
    v_add_f32_dpp v37, v37, v37 quad_perm:[1,0,3,2] row_mask:0xf bank_mask:0xf
    v_add_f32_dpp v38, v38, v38 quad_perm:[1,0,3,2] row_mask:0xf bank_mask:0xf
    v_add_f32_dpp v39, v39, v39 quad_perm:[1,0,3,2] row_mask:0xf bank_mask:0xf
    v_add_f32_dpp v40, v40, v40 quad_perm:[1,0,3,2] row_mask:0xf bank_mask:0xf
    v_add_f32_dpp v41, v41, v41 quad_perm:[1,0,3,2] row_mask:0xf bank_mask:0xf
    v_add_f32_dpp v42, v42, v42 quad_perm:[1,0,3,2] row_mask:0xf bank_mask:0xf
    v_add_f32_dpp v43, v43, v43 quad_perm:[1,0,3,2] row_mask:0xf bank_mask:0xf
    v_add_f32_dpp v44, v44, v44 quad_perm:[1,0,3,2] row_mask:0xf bank_mask:0xf
    v_add_f32_dpp v45, v45, v45 quad_perm:[1,0,3,2] row_mask:0xf bank_mask:0xf
    v_add_f32_dpp v46, v46, v46 quad_perm:[1,0,3,2] row_mask:0xf bank_mask:0xf
    v_add_f32_dpp v47, v47, v47 quad_perm:[1,0,3,2] row_mask:0xf bank_mask:0xf
    v_add_f32_dpp v32, v32, v32 quad_perm:[2,3,0,1] row_mask:0xf bank_mask:0xf
    v_add_f32_dpp v33, v33, v33 quad_perm:[2,3,0,1] row_mask:0xf bank_mask:0xf
    v_add_f32_dpp v34, v34, v34 quad_perm:[2,3,0,1] row_mask:0xf bank_mask:0xf
    v_add_f32_dpp v35, v35, v35 quad_perm:[2,3,0,1] row_mask:0xf bank_mask:0xf
    v_add_f32_dpp v36, v36, v36 quad_perm:[2,3,0,1] row_mask:0xf bank_mask:0xf
    v_add_f32_dpp v37, v37, v37 quad_perm:[2,3,0,1] row_mask:0xf bank_mask:0xf
    v_add_f32_dpp v38, v38, v38 quad_perm:[2,3,0,1] row_mask:0xf bank_mask:0xf
    v_add_f32_dpp v39, v39, v39 quad_perm:[2,3,0,1] row_mask:0xf bank_mask:0xf
    v_add_f32_dpp v40, v40, v40 quad_perm:[2,3,0,1] row_mask:0xf bank_mask:0xf
    v_add_f32_dpp v41, v41, v41 quad_perm:[2,3,0,1] row_mask:0xf bank_mask:0xf
    v_add_f32_dpp v42, v42, v42 quad_perm:[2,3,0,1] row_mask:0xf bank_mask:0xf
    v_add_f32_dpp v43, v43, v43 quad_perm:[2,3,0,1] row_mask:0xf bank_mask:0xf
    v_add_f32_dpp v44, v44, v44 quad_perm:[2,3,0,1] row_mask:0xf bank_mask:0xf
    v_add_f32_dpp v45, v45, v45 quad_perm:[2,3,0,1] row_mask:0xf bank_mask:0xf
    v_add_f32_dpp v46, v46, v46 quad_perm:[2,3,0,1] row_mask:0xf bank_mask:0xf
    v_add_f32_dpp v47, v47, v47 quad_perm:[2,3,0,1] row_mask:0xf bank_mask:0xf
    v_add_f32_dpp v32, v32, v32 row_half_mirror row_mask:0xf bank_mask:0xf
    v_add_f32_dpp v33, v33, v33 row_half_mirror row_mask:0xf bank_mask:0xf
    v_add_f32_dpp v34, v34, v34 row_half_mirror row_mask:0xf bank_mask:0xf
    v_add_f32_dpp v35, v35, v35 row_half_mirror row_mask:0xf bank_mask:0xf
    v_add_f32_dpp v36, v36, v36 row_half_mirror row_mask:0xf bank_mask:0xf
    v_add_f32_dpp v37, v37, v37 row_half_mirror row_mask:0xf bank_mask:0xf
    v_add_f32_dpp v38, v38, v38 row_half_mirror row_mask:0xf bank_mask:0xf
    v_add_f32_dpp v39, v39, v39 row_half_mirror row_mask:0xf bank_mask:0xf
    v_add_f32_dpp v40, v40, v40 row_half_mirror row_mask:0xf bank_mask:0xf
    v_add_f32_dpp v41, v41, v41 row_half_mirror row_mask:0xf bank_mask:0xf
    v_add_f32_dpp v42, v42, v42 row_half_mirror row_mask:0xf bank_mask:0xf
    v_add_f32_dpp v43, v43, v43 row_half_mirror row_mask:0xf bank_mask:0xf
    v_add_f32_dpp v44, v44, v44 row_half_mirror row_mask:0xf bank_mask:0xf
    v_add_f32_dpp v45, v45, v45 row_half_mirror row_mask:0xf bank_mask:0xf
    v_add_f32_dpp v46, v46, v46 row_half_mirror row_mask:0xf bank_mask:0xf
    v_add_f32_dpp v47, v47, v47 row_half_mirror row_mask:0xf bank_mask:0xf
    v_add_f32_dpp v32, v32, v32 row_mirror row_mask:0xf bank_mask:0xf
    v_add_f32_dpp v33, v33, v33 row_mirror row_mask:0xf bank_mask:0xf
    v_add_f32_dpp v34, v34, v34 row_mirror row_mask:0xf bank_mask:0xf
    v_add_f32_dpp v35, v35, v35 row_mirror row_mask:0xf bank_mask:0xf
    v_add_f32_dpp v36, v36, v36 row_mirror row_mask:0xf bank_mask:0xf
    v_add_f32_dpp v37, v37, v37 row_mirror row_mask:0xf bank_mask:0xf
    v_add_f32_dpp v38, v38, v38 row_mirror row_mask:0xf bank_mask:0xf
    v_add_f32_dpp v39, v39, v39 row_mirror row_mask:0xf bank_mask:0xf
    v_add_f32_dpp v40, v40, v40 row_mirror row_mask:0xf bank_mask:0xf
    v_add_f32_dpp v41, v41, v41 row_mirror row_mask:0xf bank_mask:0xf
    v_add_f32_dpp v42, v42, v42 row_mirror row_mask:0xf bank_mask:0xf
    v_add_f32_dpp v43, v43, v43 row_mirror row_mask:0xf bank_mask:0xf
    v_add_f32_dpp v44, v44, v44 row_mirror row_mask:0xf bank_mask:0xf
    v_add_f32_dpp v45, v45, v45 row_mirror row_mask:0xf bank_mask:0xf
    v_add_f32_dpp v46, v46, v46 row_mirror row_mask:0xf bank_mask:0xf
    v_add_f32_dpp v47, v47, v47 row_mirror row_mask:0xf bank_mask:0xf
    v_max3_f32 v112, v32, v33, v34
    v_max3_f32 v112, v112, v35, v36
    v_max3_f32 v112, v112, v37, v38
    v_max3_f32 v112, v112, v39, v12
    v_max3_f32 v113, v40, v41, v42
    v_max3_f32 v113, v113, v43, v44
    v_max3_f32 v113, v113, v45, v46
    v_max3_f32 v113, v113, v47, v13
    v_sub_f32 v114, v12, v112
    v_mul_f32 v114, s26, v114
    v_mul_f32 v116, s26, v112
    v_exp_f32 v114, v114
    v_mov_b32 v12, v112
    v_sub_f32 v115, v13, v113
    v_mul_f32 v115, s26, v115
    v_mul_f32 v117, s26, v113
    v_exp_f32 v115, v115
    v_mov_b32 v13, v113
    v_fma_f32 v32, v32, s26, -v116
    v_fma_f32 v33, v33, s26, -v116
    v_fma_f32 v34, v34, s26, -v116
    v_fma_f32 v35, v35, s26, -v116
    v_fma_f32 v36, v36, s26, -v116
    v_fma_f32 v37, v37, s26, -v116
    v_fma_f32 v38, v38, s26, -v116
    v_fma_f32 v39, v39, s26, -v116
    v_fma_f32 v40, v40, s26, -v117
    v_fma_f32 v41, v41, s26, -v117
    v_fma_f32 v42, v42, s26, -v117
    v_fma_f32 v43, v43, s26, -v117
    v_fma_f32 v44, v44, s26, -v117
    v_fma_f32 v45, v45, s26, -v117
    v_fma_f32 v46, v46, s26, -v117
    v_fma_f32 v47, v47, s26, -v117
    v_exp_f32 v32, v32
    v_exp_f32 v33, v33
    v_exp_f32 v34, v34
    v_exp_f32 v35, v35
    v_exp_f32 v36, v36
    v_exp_f32 v37, v37
    v_exp_f32 v38, v38
    v_exp_f32 v39, v39
    v_exp_f32 v40, v40
    v_exp_f32 v41, v41
    v_exp_f32 v42, v42
    v_exp_f32 v43, v43
    v_exp_f32 v44, v44
    v_exp_f32 v45, v45
    v_exp_f32 v46, v46
    v_exp_f32 v47, v47
    v_fma_f32 v14, v14, v114, v32
    v_add_f32 v14, v14, v33
    v_add_f32 v14, v14, v34
    v_add_f32 v14, v14, v35
    v_add_f32 v14, v14, v36
    v_add_f32 v14, v14, v37
    v_add_f32 v14, v14, v38
    v_add_f32 v14, v14, v39
    v_mul_f32 v16, v114, v16
    v_mul_f32 v17, v114, v17
    v_mul_f32 v18, v114, v18
    v_mul_f32 v19, v114, v19
    v_mul_f32 v20, v114, v20
    v_mul_f32 v21, v114, v21
    v_mul_f32 v22, v114, v22
    v_mul_f32 v23, v114, v23
    v_fma_f32 v15, v15, v115, v40
    v_add_f32 v15, v15, v41
    v_add_f32 v15, v15, v42
    v_add_f32 v15, v15, v43
    v_add_f32 v15, v15, v44
    v_add_f32 v15, v15, v45
    v_add_f32 v15, v15, v46
    v_add_f32 v15, v15, v47
    v_mul_f32 v24, v115, v24
    v_mul_f32 v25, v115, v25
    v_mul_f32 v26, v115, v26
    v_mul_f32 v27, v115, v27
    v_mul_f32 v28, v115, v28
    v_mul_f32 v29, v115, v29
    v_mul_f32 v30, v115, v30
    v_mul_f32 v31, v115, v31
    s_waitcnt vmcnt(0)
    v_lshlrev_b32 v118, 16, v80
    v_and_b32 v119, 0xffff0000, v80
    v_fmac_f32 v16, v32, v118
    v_fmac_f32 v17, v32, v119
    v_fmac_f32 v24, v40, v118
    v_fmac_f32 v25, v40, v119
    v_lshlrev_b32 v120, 16, v81
    v_and_b32 v121, 0xffff0000, v81
    v_fmac_f32 v18, v32, v120
    v_fmac_f32 v19, v32, v121
    v_fmac_f32 v26, v40, v120
    v_fmac_f32 v27, v40, v121
    v_lshlrev_b32 v118, 16, v82
    v_and_b32 v119, 0xffff0000, v82
    v_fmac_f32 v20, v32, v118
    v_fmac_f32 v21, v32, v119
    v_fmac_f32 v28, v40, v118
    v_fmac_f32 v29, v40, v119
    v_lshlrev_b32 v120, 16, v83
    v_and_b32 v121, 0xffff0000, v83
    v_fmac_f32 v22, v32, v120
    v_fmac_f32 v23, v32, v121
    v_fmac_f32 v30, v40, v120
    v_fmac_f32 v31, v40, v121
    v_lshlrev_b32 v118, 16, v84
    v_and_b32 v119, 0xffff0000, v84
    v_fmac_f32 v16, v33, v118
    v_fmac_f32 v17, v33, v119
    v_fmac_f32 v24, v41, v118
    v_fmac_f32 v25, v41, v119
    v_lshlrev_b32 v120, 16, v85
    v_and_b32 v121, 0xffff0000, v85
    v_fmac_f32 v18, v33, v120
    v_fmac_f32 v19, v33, v121
    v_fmac_f32 v26, v41, v120
    v_fmac_f32 v27, v41, v121
    v_lshlrev_b32 v118, 16, v86
    v_and_b32 v119, 0xffff0000, v86
    v_fmac_f32 v20, v33, v118
    v_fmac_f32 v21, v33, v119
    v_fmac_f32 v28, v41, v118
    v_fmac_f32 v29, v41, v119
    v_lshlrev_b32 v120, 16, v87
    v_and_b32 v121, 0xffff0000, v87
    v_fmac_f32 v22, v33, v120
    v_fmac_f32 v23, v33, v121
    v_fmac_f32 v30, v41, v120
    v_fmac_f32 v31, v41, v121
    v_lshlrev_b32 v118, 16, v88
    v_and_b32 v119, 0xffff0000, v88
    v_fmac_f32 v16, v34, v118
    v_fmac_f32 v17, v34, v119
    v_fmac_f32 v24, v42, v118
    v_fmac_f32 v25, v42, v119
    v_lshlrev_b32 v120, 16, v89
    v_and_b32 v121, 0xffff0000, v89
    v_fmac_f32 v18, v34, v120
    v_fmac_f32 v19, v34, v121
    v_fmac_f32 v26, v42, v120
    v_fmac_f32 v27, v42, v121
    v_lshlrev_b32 v118, 16, v90
    v_and_b32 v119, 0xffff0000, v90
    v_fmac_f32 v20, v34, v118
    v_fmac_f32 v21, v34, v119
    v_fmac_f32 v28, v42, v118
    v_fmac_f32 v29, v42, v119
    v_lshlrev_b32 v120, 16, v91
    v_and_b32 v121, 0xffff0000, v91
    v_fmac_f32 v22, v34, v120
    v_fmac_f32 v23, v34, v121
    v_fmac_f32 v30, v42, v120
    v_fmac_f32 v31, v42, v121
    v_lshlrev_b32 v118, 16, v92
    v_and_b32 v119, 0xffff0000, v92
    v_fmac_f32 v16, v35, v118
    v_fmac_f32 v17, v35, v119
    v_fmac_f32 v24, v43, v118
    v_fmac_f32 v25, v43, v119
    v_lshlrev_b32 v120, 16, v93
    v_and_b32 v121, 0xffff0000, v93
    v_fmac_f32 v18, v35, v120
    v_fmac_f32 v19, v35, v121
    v_fmac_f32 v26, v43, v120
    v_fmac_f32 v27, v43, v121
    v_lshlrev_b32 v118, 16, v94
    v_and_b32 v119, 0xffff0000, v94
    v_fmac_f32 v20, v35, v118
    v_fmac_f32 v21, v35, v119
    v_fmac_f32 v28, v43, v118
    v_fmac_f32 v29, v43, v119
    v_lshlrev_b32 v120, 16, v95
    v_and_b32 v121, 0xffff0000, v95
    v_fmac_f32 v22, v35, v120
    v_fmac_f32 v23, v35, v121
    v_fmac_f32 v30, v43, v120
    v_fmac_f32 v31, v43, v121
    v_lshlrev_b32 v118, 16, v96
    v_and_b32 v119, 0xffff0000, v96
    v_fmac_f32 v16, v36, v118
    v_fmac_f32 v17, v36, v119
    v_fmac_f32 v24, v44, v118
    v_fmac_f32 v25, v44, v119
    v_lshlrev_b32 v120, 16, v97
    v_and_b32 v121, 0xffff0000, v97
    v_fmac_f32 v18, v36, v120
    v_fmac_f32 v19, v36, v121
    v_fmac_f32 v26, v44, v120
    v_fmac_f32 v27, v44, v121
    v_lshlrev_b32 v118, 16, v98
    v_and_b32 v119, 0xffff0000, v98
    v_fmac_f32 v20, v36, v118
    v_fmac_f32 v21, v36, v119
    v_fmac_f32 v28, v44, v118
    v_fmac_f32 v29, v44, v119
    v_lshlrev_b32 v120, 16, v99
    v_and_b32 v121, 0xffff0000, v99
    v_fmac_f32 v22, v36, v120
    v_fmac_f32 v23, v36, v121
    v_fmac_f32 v30, v44, v120
    v_fmac_f32 v31, v44, v121
    v_lshlrev_b32 v118, 16, v100
    v_and_b32 v119, 0xffff0000, v100
    v_fmac_f32 v16, v37, v118
    v_fmac_f32 v17, v37, v119
    v_fmac_f32 v24, v45, v118
    v_fmac_f32 v25, v45, v119
    v_lshlrev_b32 v120, 16, v101
    v_and_b32 v121, 0xffff0000, v101
    v_fmac_f32 v18, v37, v120
    v_fmac_f32 v19, v37, v121
    v_fmac_f32 v26, v45, v120
    v_fmac_f32 v27, v45, v121
    v_lshlrev_b32 v118, 16, v102
    v_and_b32 v119, 0xffff0000, v102
    v_fmac_f32 v20, v37, v118
    v_fmac_f32 v21, v37, v119
    v_fmac_f32 v28, v45, v118
    v_fmac_f32 v29, v45, v119
    v_lshlrev_b32 v120, 16, v103
    v_and_b32 v121, 0xffff0000, v103
    v_fmac_f32 v22, v37, v120
    v_fmac_f32 v23, v37, v121
    v_fmac_f32 v30, v45, v120
    v_fmac_f32 v31, v45, v121
    v_lshlrev_b32 v118, 16, v104
    v_and_b32 v119, 0xffff0000, v104
    v_fmac_f32 v16, v38, v118
    v_fmac_f32 v17, v38, v119
    v_fmac_f32 v24, v46, v118
    v_fmac_f32 v25, v46, v119
    v_lshlrev_b32 v120, 16, v105
    v_and_b32 v121, 0xffff0000, v105
    v_fmac_f32 v18, v38, v120
    v_fmac_f32 v19, v38, v121
    v_fmac_f32 v26, v46, v120
    v_fmac_f32 v27, v46, v121
    v_lshlrev_b32 v118, 16, v106
    v_and_b32 v119, 0xffff0000, v106
    v_fmac_f32 v20, v38, v118
    v_fmac_f32 v21, v38, v119
    v_fmac_f32 v28, v46, v118
    v_fmac_f32 v29, v46, v119
    v_lshlrev_b32 v120, 16, v107
    v_and_b32 v121, 0xffff0000, v107
    v_fmac_f32 v22, v38, v120
    v_fmac_f32 v23, v38, v121
    v_fmac_f32 v30, v46, v120
    v_fmac_f32 v31, v46, v121
    v_lshlrev_b32 v118, 16, v108
    v_and_b32 v119, 0xffff0000, v108
    v_fmac_f32 v16, v39, v118
    v_fmac_f32 v17, v39, v119
    v_fmac_f32 v24, v47, v118
    v_fmac_f32 v25, v47, v119
    v_lshlrev_b32 v120, 16, v109
    v_and_b32 v121, 0xffff0000, v109
    v_fmac_f32 v18, v39, v120
    v_fmac_f32 v19, v39, v121
    v_fmac_f32 v26, v47, v120
    v_fmac_f32 v27, v47, v121
    v_lshlrev_b32 v118, 16, v110
    v_and_b32 v119, 0xffff0000, v110
    v_fmac_f32 v20, v39, v118
    v_fmac_f32 v21, v39, v119
    v_fmac_f32 v28, v47, v118
    v_fmac_f32 v29, v47, v119
    v_lshlrev_b32 v120, 16, v111
    v_and_b32 v121, 0xffff0000, v111
    v_fmac_f32 v22, v39, v120
    v_fmac_f32 v23, v39, v121
    v_fmac_f32 v30, v47, v120
    v_fmac_f32 v31, v47, v121
    v_lshrrev_b32 v112, 4, v3
    s_lshl_b32 s29, s20, 2
    v_add_u32 v112, s29, v112
    v_and_b32 v113, 15, v3
    v_lshlrev_b32 v114, 10, v112
    v_lshl_add_u32 v114, v113, 5, v114
    v_lshlrev_b32 v115, 4, v112
    ds_write_b128 v114, v[16:19]
    ds_write_b128 v114, v[20:23] offset:16
    ds_write_b128 v114, v[24:27] offset:512
    ds_write_b128 v114, v[28:31] offset:528
    ds_write_b128 v115, v[12:15] offset:16384
    s_waitcnt vmcnt(0) lgkmcnt(0)
    s_barrier
    v_lshrrev_b32 v1, 7, v0
    v_and_b32 v2, 127, v0
    v_lshlrev_b32 v3, 2, v1
    v_lshlrev_b32 v4, 9, v1
    v_lshl_add_u32 v4, v2, 2, v4
    ds_read_b32 v16, v3 offset:16384
    ds_read_b32 v32, v3 offset:16392
    ds_read_b32 v48, v4 offset:0
    ds_read_b32 v17, v3 offset:16400
    ds_read_b32 v33, v3 offset:16408
    ds_read_b32 v49, v4 offset:1024
    ds_read_b32 v18, v3 offset:16416
    ds_read_b32 v34, v3 offset:16424
    ds_read_b32 v50, v4 offset:2048
    ds_read_b32 v19, v3 offset:16432
    ds_read_b32 v35, v3 offset:16440
    ds_read_b32 v51, v4 offset:3072
    ds_read_b32 v20, v3 offset:16448
    ds_read_b32 v36, v3 offset:16456
    ds_read_b32 v52, v4 offset:4096
    ds_read_b32 v21, v3 offset:16464
    ds_read_b32 v37, v3 offset:16472
    ds_read_b32 v53, v4 offset:5120
    ds_read_b32 v22, v3 offset:16480
    ds_read_b32 v38, v3 offset:16488
    ds_read_b32 v54, v4 offset:6144
    ds_read_b32 v23, v3 offset:16496
    ds_read_b32 v39, v3 offset:16504
    ds_read_b32 v55, v4 offset:7168
    ds_read_b32 v24, v3 offset:16512
    ds_read_b32 v40, v3 offset:16520
    ds_read_b32 v56, v4 offset:8192
    ds_read_b32 v25, v3 offset:16528
    ds_read_b32 v41, v3 offset:16536
    ds_read_b32 v57, v4 offset:9216
    ds_read_b32 v26, v3 offset:16544
    ds_read_b32 v42, v3 offset:16552
    ds_read_b32 v58, v4 offset:10240
    ds_read_b32 v27, v3 offset:16560
    ds_read_b32 v43, v3 offset:16568
    ds_read_b32 v59, v4 offset:11264
    ds_read_b32 v28, v3 offset:16576
    ds_read_b32 v44, v3 offset:16584
    ds_read_b32 v60, v4 offset:12288
    ds_read_b32 v29, v3 offset:16592
    ds_read_b32 v45, v3 offset:16600
    ds_read_b32 v61, v4 offset:13312
    ds_read_b32 v30, v3 offset:16608
    ds_read_b32 v46, v3 offset:16616
    ds_read_b32 v62, v4 offset:14336
    ds_read_b32 v31, v3 offset:16624
    ds_read_b32 v47, v3 offset:16632
    ds_read_b32 v63, v4 offset:15360
    s_waitcnt lgkmcnt(0)
    v_max3_f32 v5, v16, v17, v18
    v_max3_f32 v5, v5, v19, v20
    v_max3_f32 v5, v5, v21, v22
    v_max3_f32 v5, v5, v23, v24
    v_max3_f32 v5, v5, v25, v26
    v_max3_f32 v5, v5, v27, v28
    v_max3_f32 v5, v5, v29, v30
    v_max_f32 v5, v5, v31
    v_sub_f32 v16, v16, v5
    v_mul_f32 v16, s26, v16
    v_sub_f32 v17, v17, v5
    v_mul_f32 v17, s26, v17
    v_sub_f32 v18, v18, v5
    v_mul_f32 v18, s26, v18
    v_sub_f32 v19, v19, v5
    v_mul_f32 v19, s26, v19
    v_sub_f32 v20, v20, v5
    v_mul_f32 v20, s26, v20
    v_sub_f32 v21, v21, v5
    v_mul_f32 v21, s26, v21
    v_sub_f32 v22, v22, v5
    v_mul_f32 v22, s26, v22
    v_sub_f32 v23, v23, v5
    v_mul_f32 v23, s26, v23
    v_sub_f32 v24, v24, v5
    v_mul_f32 v24, s26, v24
    v_sub_f32 v25, v25, v5
    v_mul_f32 v25, s26, v25
    v_sub_f32 v26, v26, v5
    v_mul_f32 v26, s26, v26
    v_sub_f32 v27, v27, v5
    v_mul_f32 v27, s26, v27
    v_sub_f32 v28, v28, v5
    v_mul_f32 v28, s26, v28
    v_sub_f32 v29, v29, v5
    v_mul_f32 v29, s26, v29
    v_sub_f32 v30, v30, v5
    v_mul_f32 v30, s26, v30
    v_sub_f32 v31, v31, v5
    v_mul_f32 v31, s26, v31
    v_exp_f32 v16, v16
    v_exp_f32 v17, v17
    v_exp_f32 v18, v18
    v_exp_f32 v19, v19
    v_exp_f32 v20, v20
    v_exp_f32 v21, v21
    v_exp_f32 v22, v22
    v_exp_f32 v23, v23
    v_exp_f32 v24, v24
    v_exp_f32 v25, v25
    v_exp_f32 v26, v26
    v_exp_f32 v27, v27
    v_exp_f32 v28, v28
    v_exp_f32 v29, v29
    v_exp_f32 v30, v30
    v_exp_f32 v31, v31
    s_nop 0
    v_mul_f32 v6, v16, v32
    v_mul_f32 v7, v16, v48
    v_fmac_f32 v6, v17, v33
    v_fmac_f32 v7, v17, v49
    v_fmac_f32 v6, v18, v34
    v_fmac_f32 v7, v18, v50
    v_fmac_f32 v6, v19, v35
    v_fmac_f32 v7, v19, v51
    v_fmac_f32 v6, v20, v36
    v_fmac_f32 v7, v20, v52
    v_fmac_f32 v6, v21, v37
    v_fmac_f32 v7, v21, v53
    v_fmac_f32 v6, v22, v38
    v_fmac_f32 v7, v22, v54
    v_fmac_f32 v6, v23, v39
    v_fmac_f32 v7, v23, v55
    v_fmac_f32 v6, v24, v40
    v_fmac_f32 v7, v24, v56
    v_fmac_f32 v6, v25, v41
    v_fmac_f32 v7, v25, v57
    v_fmac_f32 v6, v26, v42
    v_fmac_f32 v7, v26, v58
    v_fmac_f32 v6, v27, v43
    v_fmac_f32 v7, v27, v59
    v_fmac_f32 v6, v28, v44
    v_fmac_f32 v7, v28, v60
    v_fmac_f32 v6, v29, v45
    v_fmac_f32 v7, v29, v61
    v_fmac_f32 v6, v30, v46
    v_fmac_f32 v7, v30, v62
    v_fmac_f32 v6, v31, v47
    v_fmac_f32 v7, v31, v63
    s_lshl_b32 s29, s2, 10
    s_add_u32 s29, s29, 65536
    v_add_u32 v4, s29, v4
    global_store_dword v4, v7, s[8:9]
    v_cmp_eq_u32 vcc, 0, v2
    s_and_saveexec_b64 s[30:31], vcc
    s_cbranch_execz K2_exit
    s_lshl_b32 s29, s2, 4
    s_add_u32 s29, s29, 3145728
    v_lshlrev_b32 v4, 3, v1
    v_add_u32 v4, s29, v4
    v_mov_b32 v8, v5
    v_mov_b32 v9, v6
    global_store_dwordx2 v4, v[8:9], s[8:9]
K2_exit:
    s_endpgm

.p2align 8
.type out_kernel,@function
out_kernel:
    s_cmp_ge_u32 s2, 272
    s_cbranch_scc1 K3_exit
    s_load_dwordx2 s[4:5], s[0:1], 32
    s_load_dwordx2 s[6:7], s[0:1], 64
    s_load_dwordx2 s[8:9], s[0:1], 88
    v_mul_u32_u24 v1, 911, v0
    v_lshrrev_b32 v1, 16, v1
    v_mul_u32_u24 v2, 72, v1
    v_sub_u32 v2, v0, v2
    v_mul_u32_u24 v3, 9216, v1
    v_lshl_add_u32 v3, v2, 4, v3
    v_add_u32 v4, 4608, v3
    s_waitcnt lgkmcnt(0)
    s_sub_u32 s12, s2, 128
    s_cmp_ge_u32 s2, 128
    s_cselect_b32 s10, s6, s4
    s_cselect_b32 s11, s7, s5
    s_cselect_b32 s12, s12, s2
    s_mul_i32 s12, s12, 36864
    s_add_u32 s10, s10, s12
    s_addc_u32 s11, s11, 0
    global_load_dwordx4 v[32:35], v3, s[10:11] offset:0
    global_load_dwordx4 v[36:39], v3, s[10:11] offset:1152
    global_load_dwordx4 v[40:43], v3, s[10:11] offset:2304
    global_load_dwordx4 v[44:47], v3, s[10:11] offset:3456
    global_load_dwordx4 v[48:51], v4, s[10:11] offset:0
    global_load_dwordx4 v[52:55], v4, s[10:11] offset:1152
    global_load_dwordx4 v[56:59], v4, s[10:11] offset:2304
    global_load_dwordx4 v[60:63], v4, s[10:11] offset:3456
    s_mov_b32 s26, 0x3e0293ee
    s_cmp_ge_u32 s2, 128
    s_cbranch_scc1 K3_mlp_coef
    s_lshr_b32 s13, s2, 3
    s_lshr_b32 s14, s2, 2
    s_and_b32 s14, s14, 1
    s_and_b32 s15, s2, 3
    s_mul_i32 s16, s13, 128
    s_add_u32 s16, s16, s14
    v_and_b32 v5, 31, v0
    v_lshrrev_b32 v6, 5, v0
    v_mul_u32_u24 v7, 8192, v6
    v_lshl_add_u32 v7, v5, 2, v7
    s_lshl_b32 s17, s16, 9
    s_lshl_b32 s18, s15, 7
    s_add_u32 s17, s17, s18
    s_add_u32 s17, s17, 65536
    v_add_u32 v7, s17, v7
    v_cmp_gt_u32 vcc, 256, v0
    s_and_saveexec_b64 s[20:21], vcc
    s_cbranch_execz K3_skip_p2load
    global_load_dword v64, v7, s[8:9] offset:0
    global_load_dword v65, v7, s[8:9] offset:1024
    global_load_dword v66, v7, s[8:9] offset:2048
    global_load_dword v67, v7, s[8:9] offset:3072
    v_add_u32 v7, 4096, v7
    global_load_dword v68, v7, s[8:9] offset:0
    global_load_dword v69, v7, s[8:9] offset:1024
    global_load_dword v70, v7, s[8:9] offset:2048
    global_load_dword v71, v7, s[8:9] offset:3072
K3_skip_p2load:
    s_mov_b64 exec, s[20:21]
    v_lshrrev_b32 v8, 6, v0
    s_nop 0
    v_readfirstlane_b32 s19, v8
    s_cmp_lg_u32 s19, 0
    s_cbranch_scc1 K3_p1_done
    v_lshlrev_b32 v8, 4, v0
    s_lshl_b32 s17, s16, 3
    s_add_u32 s17, s17, 3145728
    v_add_u32 v8, s17, v8
    global_load_dwordx2 v[10:11], v8, s[8:9] offset:0
    s_waitcnt vmcnt(0)
    v_mov_b32 v20, v10
    s_nop 1
    v_max_f32_dpp v20, v20, v20 quad_perm:[1,0,3,2] row_mask:0xf bank_mask:0xf
    s_nop 1
    v_max_f32_dpp v20, v20, v20 quad_perm:[2,3,0,1] row_mask:0xf bank_mask:0xf
    s_nop 1
    v_max_f32_dpp v20, v20, v20 row_half_mirror row_mask:0xf bank_mask:0xf
    s_nop 1
    v_max_f32_dpp v20, v20, v20 row_mirror row_mask:0xf bank_mask:0xf
    s_nop 1
    s_nop 0
    v_readlane_b32 s28, v20, 0
    v_readlane_b32 s29, v20, 16
    v_readlane_b32 s30, v20, 32
    v_readlane_b32 s31, v20, 48
    s_nop 1
    v_mov_b32 v20, s28
    v_max_f32 v20, s29, v20
    v_max_f32 v20, s30, v20
    v_max_f32 v20, s31, v20
    v_sub_f32 v24, v10, v20
    v_mul_f32 v24, s26, v24
    v_exp_f32 v24, v24
    s_nop 0
    v_mul_f32 v21, v24, v11
    s_nop 1
    v_add_f32_dpp v21, v21, v21 quad_perm:[1,0,3,2] row_mask:0xf bank_mask:0xf
    s_nop 1
    v_add_f32_dpp v21, v21, v21 quad_perm:[2,3,0,1] row_mask:0xf bank_mask:0xf
    s_nop 1
    v_add_f32_dpp v21, v21, v21 row_half_mirror row_mask:0xf bank_mask:0xf
    s_nop 1
    v_add_f32_dpp v21, v21, v21 row_mirror row_mask:0xf bank_mask:0xf
    s_nop 1
    s_nop 0
    v_readlane_b32 s28, v21, 0
    v_readlane_b32 s29, v21, 16
    v_readlane_b32 s30, v21, 32
    v_readlane_b32 s31, v21, 48
    s_nop 1
    v_mov_b32 v21, s28
    v_add_f32 v21, s29, v21
    v_add_f32 v21, s30, v21
    v_add_f32 v21, s31, v21
    v_rcp_f32 v21, v21
    s_nop 0
    v_lshlrev_b32 v8, 2, v0
    v_mul_f32 v24, v24, v21
    ds_write_b32 v8, v24 offset:128
K3_p1_done:
    s_waitcnt vmcnt(0) lgkmcnt(0)
    s_barrier
    v_mul_u32_u24 v8, 32, v6
    ds_read_b32 v80, v8 offset:128
    ds_read_b32 v81, v8 offset:132
    ds_read_b32 v82, v8 offset:136
    ds_read_b32 v83, v8 offset:140
    ds_read_b32 v84, v8 offset:144
    ds_read_b32 v85, v8 offset:148
    ds_read_b32 v86, v8 offset:152
    ds_read_b32 v87, v8 offset:156
    s_waitcnt lgkmcnt(0)
    v_mul_f32 v20, v80, v64
    v_fmac_f32 v20, v81, v65
    v_fmac_f32 v20, v82, v66
    v_fmac_f32 v20, v83, v67
    v_fmac_f32 v20, v84, v68
    v_fmac_f32 v20, v85, v69
    v_fmac_f32 v20, v86, v70
    v_fmac_f32 v20, v87, v71
    v_lshlrev_b32 v8, 2, v0
    v_cmp_gt_u32 vcc, 256, v0
    s_and_saveexec_b64 s[20:21], vcc
    ds_write_b32 v8, v20 offset:1024
    s_mov_b64 exec, s[20:21]
    s_waitcnt lgkmcnt(0)
    s_barrier
    v_cmp_gt_u32 vcc, 32, v0
    s_and_saveexec_b64 s[20:21], vcc
    s_cbranch_execz K3_coef_done
    ds_read_b32 v12, v8 offset:1024
    ds_read_b32 v13, v8 offset:1152
    ds_read_b32 v14, v8 offset:1280
    ds_read_b32 v15, v8 offset:1408
    ds_read_b32 v16, v8 offset:1536
    ds_read_b32 v17, v8 offset:1664
    ds_read_b32 v18, v8 offset:1792
    ds_read_b32 v19, v8 offset:1920
    s_waitcnt lgkmcnt(0)
    v_add_f32 v12, v12, v13
    v_add_f32 v12, v12, v14
    v_add_f32 v12, v12, v15
    v_add_f32 v12, v12, v16
    v_add_f32 v12, v12, v17
    v_add_f32 v12, v12, v18
    v_add_f32 v12, v12, v19
    v_cvt_pk_bf16_f32 v12, v12, v12
    v_lshlrev_b32 v12, 16, v12
    ds_write_b32 v8, v12
    s_branch K3_coef_done
K3_mlp_coef:
    v_cmp_gt_u32 vcc, 32, v0
    s_and_saveexec_b64 s[20:21], vcc
    s_cbranch_execz K3_coef_done
    s_sub_u32 s13, s2, 128
    s_lshl_b32 s13, s13, 7
    s_add_u32 s13, s13, 16384
    v_lshlrev_b32 v8, 2, v0
    v_add_u32 v9, s13, v8
    global_load_dword v12, v9, s[8:9]
    s_waitcnt vmcnt(0)
    ds_write_b32 v8, v12
K3_coef_done:
    s_mov_b64 exec, s[20:21]
    s_waitcnt vmcnt(0) lgkmcnt(0)
    s_barrier
    v_lshlrev_b32 v8, 5, v1
    ds_read_b128 v[12:15], v8
    ds_read_b128 v[16:19], v8 offset:16
    v_mov_b32 v20, 0
    v_mov_b32 v21, 0
    v_mov_b32 v22, 0
    v_mov_b32 v23, 0
    v_mov_b32 v24, 0
    v_mov_b32 v25, 0
    v_mov_b32 v26, 0
    v_mov_b32 v27, 0
    s_waitcnt lgkmcnt(0)
    v_lshlrev_b32 v28, 16, v32
    v_and_b32 v29, 0xffff0000, v32
    v_fmac_f32 v20, v12, v28
    v_fmac_f32 v21, v12, v29
    v_lshlrev_b32 v28, 16, v33
    v_and_b32 v29, 0xffff0000, v33
    v_fmac_f32 v22, v12, v28
    v_fmac_f32 v23, v12, v29
    v_lshlrev_b32 v28, 16, v34
    v_and_b32 v29, 0xffff0000, v34
    v_fmac_f32 v24, v12, v28
    v_fmac_f32 v25, v12, v29
    v_lshlrev_b32 v28, 16, v35
    v_and_b32 v29, 0xffff0000, v35
    v_fmac_f32 v26, v12, v28
    v_fmac_f32 v27, v12, v29
    v_lshlrev_b32 v28, 16, v36
    v_and_b32 v29, 0xffff0000, v36
    v_fmac_f32 v20, v13, v28
    v_fmac_f32 v21, v13, v29
    v_lshlrev_b32 v28, 16, v37
    v_and_b32 v29, 0xffff0000, v37
    v_fmac_f32 v22, v13, v28
    v_fmac_f32 v23, v13, v29
    v_lshlrev_b32 v28, 16, v38
    v_and_b32 v29, 0xffff0000, v38
    v_fmac_f32 v24, v13, v28
    v_fmac_f32 v25, v13, v29
    v_lshlrev_b32 v28, 16, v39
    v_and_b32 v29, 0xffff0000, v39
    v_fmac_f32 v26, v13, v28
    v_fmac_f32 v27, v13, v29
    v_lshlrev_b32 v28, 16, v40
    v_and_b32 v29, 0xffff0000, v40
    v_fmac_f32 v20, v14, v28
    v_fmac_f32 v21, v14, v29
    v_lshlrev_b32 v28, 16, v41
    v_and_b32 v29, 0xffff0000, v41
    v_fmac_f32 v22, v14, v28
    v_fmac_f32 v23, v14, v29
    v_lshlrev_b32 v28, 16, v42
    v_and_b32 v29, 0xffff0000, v42
    v_fmac_f32 v24, v14, v28
    v_fmac_f32 v25, v14, v29
    v_lshlrev_b32 v28, 16, v43
    v_and_b32 v29, 0xffff0000, v43
    v_fmac_f32 v26, v14, v28
    v_fmac_f32 v27, v14, v29
    v_lshlrev_b32 v28, 16, v44
    v_and_b32 v29, 0xffff0000, v44
    v_fmac_f32 v20, v15, v28
    v_fmac_f32 v21, v15, v29
    v_lshlrev_b32 v28, 16, v45
    v_and_b32 v29, 0xffff0000, v45
    v_fmac_f32 v22, v15, v28
    v_fmac_f32 v23, v15, v29
    v_lshlrev_b32 v28, 16, v46
    v_and_b32 v29, 0xffff0000, v46
    v_fmac_f32 v24, v15, v28
    v_fmac_f32 v25, v15, v29
    v_lshlrev_b32 v28, 16, v47
    v_and_b32 v29, 0xffff0000, v47
    v_fmac_f32 v26, v15, v28
    v_fmac_f32 v27, v15, v29
    v_lshlrev_b32 v28, 16, v48
    v_and_b32 v29, 0xffff0000, v48
    v_fmac_f32 v20, v16, v28
    v_fmac_f32 v21, v16, v29
    v_lshlrev_b32 v28, 16, v49
    v_and_b32 v29, 0xffff0000, v49
    v_fmac_f32 v22, v16, v28
    v_fmac_f32 v23, v16, v29
    v_lshlrev_b32 v28, 16, v50
    v_and_b32 v29, 0xffff0000, v50
    v_fmac_f32 v24, v16, v28
    v_fmac_f32 v25, v16, v29
    v_lshlrev_b32 v28, 16, v51
    v_and_b32 v29, 0xffff0000, v51
    v_fmac_f32 v26, v16, v28
    v_fmac_f32 v27, v16, v29
    v_lshlrev_b32 v28, 16, v52
    v_and_b32 v29, 0xffff0000, v52
    v_fmac_f32 v20, v17, v28
    v_fmac_f32 v21, v17, v29
    v_lshlrev_b32 v28, 16, v53
    v_and_b32 v29, 0xffff0000, v53
    v_fmac_f32 v22, v17, v28
    v_fmac_f32 v23, v17, v29
    v_lshlrev_b32 v28, 16, v54
    v_and_b32 v29, 0xffff0000, v54
    v_fmac_f32 v24, v17, v28
    v_fmac_f32 v25, v17, v29
    v_lshlrev_b32 v28, 16, v55
    v_and_b32 v29, 0xffff0000, v55
    v_fmac_f32 v26, v17, v28
    v_fmac_f32 v27, v17, v29
    v_lshlrev_b32 v28, 16, v56
    v_and_b32 v29, 0xffff0000, v56
    v_fmac_f32 v20, v18, v28
    v_fmac_f32 v21, v18, v29
    v_lshlrev_b32 v28, 16, v57
    v_and_b32 v29, 0xffff0000, v57
    v_fmac_f32 v22, v18, v28
    v_fmac_f32 v23, v18, v29
    v_lshlrev_b32 v28, 16, v58
    v_and_b32 v29, 0xffff0000, v58
    v_fmac_f32 v24, v18, v28
    v_fmac_f32 v25, v18, v29
    v_lshlrev_b32 v28, 16, v59
    v_and_b32 v29, 0xffff0000, v59
    v_fmac_f32 v26, v18, v28
    v_fmac_f32 v27, v18, v29
    v_lshlrev_b32 v28, 16, v60
    v_and_b32 v29, 0xffff0000, v60
    v_fmac_f32 v20, v19, v28
    v_fmac_f32 v21, v19, v29
    v_lshlrev_b32 v28, 16, v61
    v_and_b32 v29, 0xffff0000, v61
    v_fmac_f32 v22, v19, v28
    v_fmac_f32 v23, v19, v29
    v_lshlrev_b32 v28, 16, v62
    v_and_b32 v29, 0xffff0000, v62
    v_fmac_f32 v24, v19, v28
    v_fmac_f32 v25, v19, v29
    v_lshlrev_b32 v28, 16, v63
    v_and_b32 v29, 0xffff0000, v63
    v_fmac_f32 v26, v19, v28
    v_fmac_f32 v27, v19, v29
    v_mul_u32_u24 v8, 2304, v1
    v_lshl_add_u32 v8, v2, 5, v8
    ds_write_b128 v8, v[20:23] offset:2048
    ds_write_b128 v8, v[24:27] offset:2064
    s_waitcnt lgkmcnt(0)
    s_barrier
    v_lshlrev_b32 v8, 3, v0
    ds_read_b64 v[12:13], v8 offset:2048
    ds_read_b64 v[14:15], v8 offset:4352
    ds_read_b64 v[16:17], v8 offset:6656
    ds_read_b64 v[18:19], v8 offset:8960
    s_waitcnt lgkmcnt(0)
    v_add_f32 v12, v12, v14
    v_add_f32 v13, v13, v15
    v_add_f32 v12, v12, v16
    v_add_f32 v13, v13, v17
    v_add_f32 v12, v12, v18
    v_add_f32 v13, v13, v19
    s_mul_i32 s13, s2, 2304
    s_add_u32 s13, s13, 4194304
    v_add_u32 v8, s13, v8
    global_store_dwordx2 v8, v[12:13], s[8:9]
K3_exit:
    s_endpgm

.p2align 8
.type fin_kernel,@function
fin_kernel:
    s_cmp_ge_u32 s2, 9
    s_cbranch_scc1 K4_exit
    s_load_dwordx2 s[4:5], s[0:1], 0
    s_load_dwordx2 s[6:7], s[0:1], 72
    s_load_dwordx2 s[8:9], s[0:1], 88
    v_and_b32 v1, 63, v0
    v_lshrrev_b32 v2, 6, v0
    s_lshl_b32 s10, s2, 8
    s_add_u32 s10, s10, 4194304
    v_lshlrev_b32 v3, 2, v1
    v_add_u32 v3, s10, v3
    v_mul_u32_u24 v4, 73728, v2
    v_mul_u32_u24 v5, 82944, v2
    v_add_u32 v4, v4, v3
    v_add_u32 v5, v5, v3
    v_add_u32 v5, 294912, v5
    s_waitcnt lgkmcnt(0)
    global_load_dword v16, v4, s[8:9]
    v_add_u32 v4, 2304, v4
    global_load_dword v17, v4, s[8:9]
    v_add_u32 v4, 2304, v4
    global_load_dword v18, v4, s[8:9]
    v_add_u32 v4, 2304, v4
    global_load_dword v19, v4, s[8:9]
    v_add_u32 v4, 2304, v4
    global_load_dword v20, v4, s[8:9]
    v_add_u32 v4, 2304, v4
    global_load_dword v21, v4, s[8:9]
    v_add_u32 v4, 2304, v4
    global_load_dword v22, v4, s[8:9]
    v_add_u32 v4, 2304, v4
    global_load_dword v23, v4, s[8:9]
    v_add_u32 v4, 2304, v4
    global_load_dword v24, v4, s[8:9]
    v_add_u32 v4, 2304, v4
    global_load_dword v25, v4, s[8:9]
    v_add_u32 v4, 2304, v4
    global_load_dword v26, v4, s[8:9]
    v_add_u32 v4, 2304, v4
    global_load_dword v27, v4, s[8:9]
    v_add_u32 v4, 2304, v4
    global_load_dword v28, v4, s[8:9]
    v_add_u32 v4, 2304, v4
    global_load_dword v29, v4, s[8:9]
    v_add_u32 v4, 2304, v4
    global_load_dword v30, v4, s[8:9]
    v_add_u32 v4, 2304, v4
    global_load_dword v31, v4, s[8:9]
    v_add_u32 v4, 2304, v4
    global_load_dword v32, v4, s[8:9]
    v_add_u32 v4, 2304, v4
    global_load_dword v33, v4, s[8:9]
    v_add_u32 v4, 2304, v4
    global_load_dword v34, v4, s[8:9]
    v_add_u32 v4, 2304, v4
    global_load_dword v35, v4, s[8:9]
    v_add_u32 v4, 2304, v4
    global_load_dword v36, v4, s[8:9]
    v_add_u32 v4, 2304, v4
    global_load_dword v37, v4, s[8:9]
    v_add_u32 v4, 2304, v4
    global_load_dword v38, v4, s[8:9]
    v_add_u32 v4, 2304, v4
    global_load_dword v39, v4, s[8:9]
    v_add_u32 v4, 2304, v4
    global_load_dword v40, v4, s[8:9]
    v_add_u32 v4, 2304, v4
    global_load_dword v41, v4, s[8:9]
    v_add_u32 v4, 2304, v4
    global_load_dword v42, v4, s[8:9]
    v_add_u32 v4, 2304, v4
    global_load_dword v43, v4, s[8:9]
    v_add_u32 v4, 2304, v4
    global_load_dword v44, v4, s[8:9]
    v_add_u32 v4, 2304, v4
    global_load_dword v45, v4, s[8:9]
    v_add_u32 v4, 2304, v4
    global_load_dword v46, v4, s[8:9]
    v_add_u32 v4, 2304, v4
    global_load_dword v47, v4, s[8:9]
    v_add_u32 v4, 2304, v4
    global_load_dword v48, v5, s[8:9]
    v_add_u32 v5, 2304, v5
    global_load_dword v49, v5, s[8:9]
    v_add_u32 v5, 2304, v5
    global_load_dword v50, v5, s[8:9]
    v_add_u32 v5, 2304, v5
    global_load_dword v51, v5, s[8:9]
    v_add_u32 v5, 2304, v5
    global_load_dword v52, v5, s[8:9]
    v_add_u32 v5, 2304, v5
    global_load_dword v53, v5, s[8:9]
    v_add_u32 v5, 2304, v5
    global_load_dword v54, v5, s[8:9]
    v_add_u32 v5, 2304, v5
    global_load_dword v55, v5, s[8:9]
    v_add_u32 v5, 2304, v5
    global_load_dword v56, v5, s[8:9]
    v_add_u32 v5, 2304, v5
    global_load_dword v57, v5, s[8:9]
    v_add_u32 v5, 2304, v5
    global_load_dword v58, v5, s[8:9]
    v_add_u32 v5, 2304, v5
    global_load_dword v59, v5, s[8:9]
    v_add_u32 v5, 2304, v5
    global_load_dword v60, v5, s[8:9]
    v_add_u32 v5, 2304, v5
    global_load_dword v61, v5, s[8:9]
    v_add_u32 v5, 2304, v5
    global_load_dword v62, v5, s[8:9]
    v_add_u32 v5, 2304, v5
    global_load_dword v63, v5, s[8:9]
    v_add_u32 v5, 2304, v5
    global_load_dword v64, v5, s[8:9]
    v_add_u32 v5, 2304, v5
    global_load_dword v65, v5, s[8:9]
    v_add_u32 v5, 2304, v5
    global_load_dword v66, v5, s[8:9]
    v_add_u32 v5, 2304, v5
    global_load_dword v67, v5, s[8:9]
    v_add_u32 v5, 2304, v5
    global_load_dword v68, v5, s[8:9]
    v_add_u32 v5, 2304, v5
    global_load_dword v69, v5, s[8:9]
    v_add_u32 v5, 2304, v5
    global_load_dword v70, v5, s[8:9]
    v_add_u32 v5, 2304, v5
    global_load_dword v71, v5, s[8:9]
    v_add_u32 v5, 2304, v5
    global_load_dword v72, v5, s[8:9]
    v_add_u32 v5, 2304, v5
    global_load_dword v73, v5, s[8:9]
    v_add_u32 v5, 2304, v5
    global_load_dword v74, v5, s[8:9]
    v_add_u32 v5, 2304, v5
    global_load_dword v75, v5, s[8:9]
    v_add_u32 v5, 2304, v5
    global_load_dword v76, v5, s[8:9]
    v_add_u32 v5, 2304, v5
    global_load_dword v77, v5, s[8:9]
    v_add_u32 v5, 2304, v5
    global_load_dword v78, v5, s[8:9]
    v_add_u32 v5, 2304, v5
    global_load_dword v79, v5, s[8:9]
    v_add_u32 v5, 2304, v5
    global_load_dword v80, v5, s[8:9]
    v_add_u32 v5, 2304, v5
    global_load_dword v81, v5, s[8:9]
    v_add_u32 v5, 2304, v5
    global_load_dword v82, v5, s[8:9]
    v_add_u32 v5, 2304, v5
    global_load_dword v83, v5, s[8:9]
    v_add_u32 v5, 2304, v5
    s_waitcnt vmcnt(36)
    v_add_f32 v16, v16, v17
    v_add_f32 v16, v16, v18
    v_add_f32 v16, v16, v19
    v_add_f32 v16, v16, v20
    v_add_f32 v16, v16, v21
    v_add_f32 v16, v16, v22
    v_add_f32 v16, v16, v23
    v_add_f32 v16, v16, v24
    v_add_f32 v16, v16, v25
    v_add_f32 v16, v16, v26
    v_add_f32 v16, v16, v27
    v_add_f32 v16, v16, v28
    v_add_f32 v16, v16, v29
    v_add_f32 v16, v16, v30
    v_add_f32 v16, v16, v31
    v_add_f32 v16, v16, v32
    v_add_f32 v16, v16, v33
    v_add_f32 v16, v16, v34
    v_add_f32 v16, v16, v35
    v_add_f32 v16, v16, v36
    v_add_f32 v16, v16, v37
    v_add_f32 v16, v16, v38
    v_add_f32 v16, v16, v39
    v_add_f32 v16, v16, v40
    v_add_f32 v16, v16, v41
    v_add_f32 v16, v16, v42
    v_add_f32 v16, v16, v43
    v_add_f32 v16, v16, v44
    v_add_f32 v16, v16, v45
    v_add_f32 v16, v16, v46
    v_add_f32 v16, v16, v47
    s_waitcnt vmcnt(0)
    v_add_f32 v48, v48, v49
    v_add_f32 v48, v48, v50
    v_add_f32 v48, v48, v51
    v_add_f32 v48, v48, v52
    v_add_f32 v48, v48, v53
    v_add_f32 v48, v48, v54
    v_add_f32 v48, v48, v55
    v_add_f32 v48, v48, v56
    v_add_f32 v48, v48, v57
    v_add_f32 v48, v48, v58
    v_add_f32 v48, v48, v59
    v_add_f32 v48, v48, v60
    v_add_f32 v48, v48, v61
    v_add_f32 v48, v48, v62
    v_add_f32 v48, v48, v63
    v_add_f32 v48, v48, v64
    v_add_f32 v48, v48, v65
    v_add_f32 v48, v48, v66
    v_add_f32 v48, v48, v67
    v_add_f32 v48, v48, v68
    v_add_f32 v48, v48, v69
    v_add_f32 v48, v48, v70
    v_add_f32 v48, v48, v71
    v_add_f32 v48, v48, v72
    v_add_f32 v48, v48, v73
    v_add_f32 v48, v48, v74
    v_add_f32 v48, v48, v75
    v_add_f32 v48, v48, v76
    v_add_f32 v48, v48, v77
    v_add_f32 v48, v48, v78
    v_add_f32 v48, v48, v79
    v_add_f32 v48, v48, v80
    v_add_f32 v48, v48, v81
    v_add_f32 v48, v48, v82
    v_add_f32 v48, v48, v83
    v_lshlrev_b32 v6, 2, v0
    ds_write_b32 v6, v16
    ds_write_b32 v6, v48 offset:1024
    s_waitcnt lgkmcnt(0)
    s_barrier
    v_cmp_gt_u32 vcc, 64, v0
    s_and_saveexec_b64 s[20:21], vcc
    s_cbranch_execz K4_exit
    ds_read_b32 v8, v6 offset:0
    ds_read_b32 v12, v6 offset:1024
    ds_read_b32 v9, v6 offset:256
    ds_read_b32 v13, v6 offset:1280
    ds_read_b32 v10, v6 offset:512
    ds_read_b32 v14, v6 offset:1536
    ds_read_b32 v11, v6 offset:768
    ds_read_b32 v15, v6 offset:1792
    s_lshl_b32 s10, s2, 7
    v_lshlrev_b32 v7, 1, v1
    v_add_u32 v7, s10, v7
    global_load_ushort v16, v7, s[4:5]
    s_waitcnt lgkmcnt(0)
    v_add_f32 v8, v8, v9
    v_add_f32 v10, v10, v11
    v_add_f32 v8, v8, v10
    v_add_f32 v12, v12, v13
    v_add_f32 v14, v14, v15
    v_add_f32 v12, v12, v14
    v_cvt_pk_bf16_f32 v9, v8, v12
    v_lshlrev_b32 v8, 16, v9
    v_and_b32 v12, 0xffff0000, v9
    v_mul_f32 v13, 0xbfb8aa3b, v12
    v_exp_f32 v13, v13
    s_nop 0
    v_add_f32 v13, 1.0, v13
    v_rcp_f32 v13, v13
    s_nop 0
    v_mul_f32 v13, v12, v13
    v_cvt_pk_bf16_f32 v13, v13, v13
    v_lshlrev_b32 v13, 16, v13
    v_mul_f32 v13, v8, v13
    v_cvt_pk_bf16_f32 v13, v13, v13
    v_lshlrev_b32 v13, 16, v13
    s_waitcnt vmcnt(0)
    v_lshlrev_b32 v16, 16, v16
    v_add_f32 v13, v16, v13
    v_cvt_pk_bf16_f32 v13, v13, v13
    global_store_short v7, v13, s[6:7]
K4_exit:
    s_endpgm

.section .rodata,"a"
.p2align 6
.amdhsa_kernel proj_kernel
  .amdhsa_next_free_vgpr 128
  .amdhsa_next_free_sgpr 96
  .amdhsa_accum_offset 128
  .amdhsa_group_segment_fixed_size 0
  .amdhsa_kernarg_size 96
  .amdhsa_user_sgpr_count 2
  .amdhsa_user_sgpr_kernarg_segment_ptr 1
  .amdhsa_system_sgpr_workgroup_id_x 1
.end_amdhsa_kernel
.amdhsa_kernel attn_kernel
  .amdhsa_next_free_vgpr 128
  .amdhsa_next_free_sgpr 96
  .amdhsa_accum_offset 128
  .amdhsa_group_segment_fixed_size 0
  .amdhsa_kernarg_size 96
  .amdhsa_user_sgpr_count 2
  .amdhsa_user_sgpr_kernarg_segment_ptr 1
  .amdhsa_system_sgpr_workgroup_id_x 1
.end_amdhsa_kernel
.amdhsa_kernel out_kernel
  .amdhsa_next_free_vgpr 96
  .amdhsa_next_free_sgpr 96
  .amdhsa_accum_offset 96
  .amdhsa_group_segment_fixed_size 0
  .amdhsa_kernarg_size 96
  .amdhsa_user_sgpr_count 2
  .amdhsa_user_sgpr_kernarg_segment_ptr 1
  .amdhsa_system_sgpr_workgroup_id_x 1
.end_amdhsa_kernel
.amdhsa_kernel fin_kernel
  .amdhsa_next_free_vgpr 84
  .amdhsa_next_free_sgpr 96
  .amdhsa_accum_offset 84
  .amdhsa_group_segment_fixed_size 0
  .amdhsa_kernarg_size 96
  .amdhsa_user_sgpr_count 2
  .amdhsa_user_sgpr_kernarg_segment_ptr 1
  .amdhsa_system_sgpr_workgroup_id_x 1
.end_amdhsa_kernel
```
